```python
import torch

def _softmax(x, axis=-1):
    return torch.softmax(x, dim=axis)
def _gelu(x):
    return torch.nn.functional.gelu(x, approximate="tanh")
def _silu(x):
    return torch.nn.functional.silu(x)
def _sigmoid(x):
    return torch.sigmoid(x)
def _layernorm(x, axis=-1, eps=1e-5):
    m = x.mean(dim=axis, keepdim=True)
    v = x.var(dim=axis, keepdim=True, unbiased=False)
    return (x - m) / torch.sqrt(v + eps)
def _scatter_add(tgt, idx, src, axis=0):
    return tgt.clone().index_add_(axis, idx, src)
def _segment_sum(src, seg, n):
    out = torch.zeros((n,) + src.shape[1:], dtype=src.dtype)
    return out.index_add_(0, seg, src)
def _pad(x, pw):
    flat = tuple(v for pair in reversed(pw) for v in pair)
    return torch.nn.functional.pad(x, flat)

kernel_name = 'concat_heads__ssm_conv_s4d__ssm_conv_s5__prompt'

def setup_inputs():

    _w = (lambda a: (lambda t: t.to(torch.bfloat16) if t.is_floating_point() else t)(torch.as_tensor(a)))
    def _A_setup():
        Bsz, L, D, N = 1, 2048, 576, 128
        return {
            "u": _w((lambda *s: torch.randn(*s, dtype=torch.bfloat16) * 0.05)(Bsz, L, D)),
            "log_A_real": _w((lambda *s: torch.randn(*s, dtype=torch.bfloat16) * 3.2)(D, N) * 0.5),
            "A_imag": _w((lambda *s: torch.randn(*s, dtype=torch.bfloat16) * 0.05)(D, N) * 3.14),
            "C_real": _w((lambda *s: torch.randn(*s, dtype=torch.bfloat16) * 0.1)(D, N) / N ** 0.5),
            "C_imag": _w((lambda *s: torch.randn(*s, dtype=torch.bfloat16) * 0.1)(D, N) / N ** 0.5),
            "log_dt": _w((lambda *s: torch.randn(*s, dtype=torch.bfloat16) * 0.05)(D) * 0.5 - 4.0),
            "D_skip": _w((lambda *s: torch.randn(*s, dtype=torch.bfloat16) * 0.05)(D)),
        }
    _A_in = _A_setup()

    def _B_setup():
        B, S, D = 1, 2048, 576
        P = D
        Lambda_re = -0.5 * (lambda _x: torch.exp(torch.as_tensor(_x)))((lambda *s: torch.randn(*s, dtype=torch.bfloat16) * 0.2)(P))
        Lambda_im = (lambda *s: torch.randn(*s, dtype=torch.bfloat16) * 0.4)(P) * 1.0
        B_re = (lambda *s: torch.randn(*s, dtype=torch.bfloat16) * 0.2)(P, D) * (D ** -0.5)
        B_im = (lambda *s: torch.randn(*s, dtype=torch.bfloat16) * 0.2)(P, D) * (D ** -0.5)
        C_re = (lambda *s: torch.randn(*s, dtype=torch.bfloat16) * 0.2)(D, P) * (P ** -0.5)
        C_im = (lambda *s: torch.randn(*s, dtype=torch.bfloat16) * 0.2)(D, P) * (P ** -0.5)
        log_dt = (lambda *s: torch.randn(*s, dtype=torch.bfloat16) * 0.2)(P) * 0.3 - 2.0
        Dskip = (lambda *s: torch.randn(*s, dtype=torch.bfloat16) * 0.05)(D)
        return {
            "x": _w((lambda *s: torch.randn(*s, dtype=torch.bfloat16) * 0.05)(B, S, D)),
            "Lambda_re": _w(Lambda_re),
            "Lambda_im": _w(Lambda_im),
            "B_re": _w(B_re),
            "B_im": _w(B_im),
            "C_re": _w(C_re),
            "C_im": _w(C_im),
            "log_dt": _w(log_dt),
            "Dskip": _w(Dskip),
        }
    _B_in = _B_setup()

    return {
        "A_u": _A_in["u"],
        "A_log_A_real": _A_in["log_A_real"],
        "A_A_imag": _A_in["A_imag"],
        "A_C_real": _A_in["C_real"],
        "A_C_imag": _A_in["C_imag"],
        "A_log_dt": _A_in["log_dt"],
        "A_D_skip": _A_in["D_skip"],
        "B_x": _B_in["x"],
        "B_Lambda_re": _B_in["Lambda_re"],
        "B_Lambda_im": _B_in["Lambda_im"],
        "B_B_re": _B_in["B_re"],
        "B_B_im": _B_in["B_im"],
        "B_C_re": _B_in["C_re"],
        "B_C_im": _B_in["C_im"],
        "B_log_dt": _B_in["log_dt"],
        "B_Dskip": _B_in["Dskip"],
    }

def reference(A_u, A_log_A_real, A_A_imag, A_C_real, A_C_imag, A_log_dt, A_D_skip, B_x, B_Lambda_re, B_Lambda_im, B_B_re, B_B_im, B_C_re, B_C_im, B_log_dt, B_Dskip):
    def _A_ref(u, log_A_real, A_imag, C_real, C_imag, log_dt, D_skip):
        L = u.shape[1]
        dt = torch.exp(log_dt)
        A = -torch.exp(log_A_real) + 1j * A_imag
        C = (C_real + 1j * C_imag) * dt[:, None]
        pos = (lambda x, dt: x.to(dt))(torch.arange(L), log_dt.dtype)
        P = torch.exp((A * dt[:, None])[:, :, None] * pos[None, None, :])
        K = 2.0 * torch.einsum("dn,dnl->dl", C, P).real
        L2 = 2 * L
        u_t = (lambda x, *d: x.permute(*d))(u, 0, 2, 1)
        Kf = (lambda x, *a, **k: torch.fft.rfft(x.float(), *a, **k))(K, L2)
        Uf = (lambda x, *a, **k: torch.fft.rfft(x.float(), *a, **k))(u_t, L2)
        y = (lambda x, *a, **k: torch.fft.irfft(x, *a, **k).to(torch.bfloat16))(Uf * Kf[None, :, :], L2)[:, :, :L]
        y = (lambda x, *d: x.permute(*d))(y, 0, 2, 1)
        return y + u * D_skip[None, None, :]

    def _B_ref(x, Lambda_re, Lambda_im, B_re, B_im, C_re, C_im, log_dt, Dskip):
        Bsz, L, H = x.shape
        Lam = Lambda_re + 1j * Lambda_im
        Bmat = B_re + 1j * B_im
        Cmat = C_re + 1j * C_im
        dt = torch.exp(log_dt)
        Lam_bar = torch.exp(dt * Lam)
        B_bar = ((Lam_bar - 1.0) / Lam)[:, None] * Bmat
        Bu = torch.einsum("bld,pd->blp", x + 0j, B_bar)
        h = torch.zeros_like(Bu[:, 0, :])
        hs = []
        for t in range(L):
            h = Lam_bar[None, :] * h + Bu[:, t, :]
            hs.append(h)
        hseq = torch.stack(hs, 1)
        y = 2.0 * torch.einsum("blp,dp->bld", hseq, Cmat).real + x * Dskip[None, None, :]
        return y

    a = _A_ref(A_u, A_log_A_real, A_A_imag, A_C_real, A_C_imag, A_log_dt, A_D_skip)
    b = _B_ref(B_x, B_Lambda_re, B_Lambda_im, B_B_re, B_B_im, B_C_re, B_C_im, B_log_dt, B_Dskip)
    return torch.concatenate([a, b], axis=-1)
```

```asm
; @launch grid=(256,1,1) block=(512,1,1) lds=163840
.amdgcn_target "amdgcn-amd-amdhsa--gfx950"
.text
.globl concat_heads__ssm_conv_s4d__ssm_conv_s5__prompt_kernel
.p2align 8
.type concat_heads__ssm_conv_s4d__ssm_conv_s5__prompt_kernel,@function
concat_heads__ssm_conv_s4d__ssm_conv_s5__prompt_kernel:
Lstart:
    s_cmp_ge_u32 s2, 256
    s_cbranch_scc1 Lexit
    s_and_b32 s3, s2, 7
    s_lshr_b32 s4, s2, 3
    s_cmp_ge_u32 s4, 24
    s_cselect_b32 s8, 0, 56
    s_load_dwordx16 s[16:31], s[0:1], s8
    s_load_dwordx8 s[32:39], s[0:1], 120
    v_lshrrev_b32 v1, 6, v0
    s_getpc_b64 s[10:11]
Lpc:
    v_readfirstlane_b32 s5, v1
    s_lshl_b32 s9, s4, 11
    v_lshl_add_u32 v1, v0, 2, s9
    v_min_u32 v1, Lcode_end-Lpc-4, v1
    global_load_dword v255, v1, s[10:11]
    v_and_b32 v0, 63, v0
    s_cmp_ge_u32 s4, 24
    s_cbranch_scc1 LA_entry
    s_mul_i32 s79, s4, 43
    s_lshr_b32 s79, s79, 8
    s_lshr_b32 s70, s79, 1
    s_lshl_b32 s56, s3, 1
    s_add_u32 s56, s56, s70
    s_mul_i32 s72, s70, 12
    s_sub_u32 s57, s4, s72
    s_cmp_ge_u32 s5, 4
    s_cbranch_scc0 LB_compute
    s_cmp_ge_u32 s5, 6
    s_cbranch_scc1 LB_const
    s_mul_i32 s74, s57, 171
    s_lshr_b32 s74, s74, 8
    s_lshl_b32 s70, s70, 2
    s_add_u32 s74, s74, s70
    s_add_u32 s74, s74, s3
    s_and_b32 s74, s74, 7
    s_lshl_b32 s74, s74, 7
    s_movk_i32 s60, 1024
    s_sub_u32 s78, s5, 4
    v_bfe_u32 v2, v0, 3, 2
    v_and_b32 v3, 1, v2
    v_lshrrev_b32 v2, 1, v2
    v_lshl_add_u32 v2, v3, 2, v2
    v_lshrrev_b32 v3, 5, v0
    v_lshl_add_u32 v2, v3, 3, v2
    v_bfe_u32 v3, v0, 4, 2
    v_and_b32 v4, 7, v0
    v_xor_b32 v3, v3, v4
    v_lshlrev_b32 v3, 4, v3
    v_mul_u32_u24 v2, 1152, v2
    v_add_u32 v2, v2, v3
    v_lshrrev_b32 v4, 3, v0
    v_mul_u32_u24 v4, 1152, v4
    v_add_u32 v4, v4, v3
    v_xor_b32 v3, 64, v2
    v_add_u32 v3, 18432, v3
    v_xor_b32 v5, 64, v4
    v_add_u32 v5, 9216, v5
    s_lshl_b32 s71, s56, 7
    s_lshl_b32 s72, s78, 6
    s_add_u32 s71, s71, s72
    s_mul_i32 s61, s71, 1152
    s_add_u32 s62, s61, 2304
    s_add_u32 s63, s61, 36864
    s_add_u32 s64, s61, 39168
    s_mul_i32 s65, s57, 55296
    s_add_u32 s66, s65, 18432
    s_add_u32 s67, s65, 36864
    s_lshl_b32 s68, s78, 13
    s_mul_i32 s69, s78, 6144
    s_add_u32 s69, s69, 16384
    s_waitcnt lgkmcnt(0)
    s_mov_b32 s44, s16
    s_and_b32 s45, s17, 0xffff
    s_mov_b32 s46, 2359296
    s_mov_b32 s47, 0x20000
    s_cmp_ge_u32 s78, 1
    s_cselect_b32 s48, s24, s22
    s_cselect_b32 s49, s25, s23
    s_and_b32 s49, s49, 0xffff
    s_mov_b32 s50, 663552
    s_mov_b32 s51, 0x20000
    s_mov_b32 s73, 0
    s_getpc_b64 s[30:31]
LB_i0:
    s_add_u32 s30, s30, LB_i1-LB_i0
    s_addc_u32 s31, s31, 0
LB_issue:
    v_add_u32 v6, s60, v2
    v_add_u32 v7, s60, v3
    v_add_u32 v8, s60, v4
    v_add_u32 v9, s60, v5
    s_add_u32 s71, s73, s68
    s_add_u32 s72, s73, s69
    s_mov_b32 s60, s74
    s_add_u32 s74, s74, 128
    s_and_b32 s74, s74, 1023
    s_add_u32 m0, s71, 0
    s_nop 0
    buffer_load_dwordx4 v6, s[44:47], s61 offen lds
    s_add_u32 m0, s71, 1024
    s_nop 0
    buffer_load_dwordx4 v7, s[44:47], s61 offen lds
    s_add_u32 m0, s71, 2048
    s_nop 0
    buffer_load_dwordx4 v6, s[44:47], s62 offen lds
    s_add_u32 m0, s71, 3072
    s_nop 0
    buffer_load_dwordx4 v7, s[44:47], s62 offen lds
    s_add_u32 m0, s71, 4096
    s_nop 0
    buffer_load_dwordx4 v6, s[44:47], s63 offen lds
    s_add_u32 m0, s71, 5120
    s_nop 0
    buffer_load_dwordx4 v7, s[44:47], s63 offen lds
    s_add_u32 m0, s71, 6144
    s_nop 0
    buffer_load_dwordx4 v6, s[44:47], s64 offen lds
    s_add_u32 m0, s71, 7168
    s_nop 0
    buffer_load_dwordx4 v7, s[44:47], s64 offen lds
    s_add_u32 m0, s72, 0
    s_nop 0
    buffer_load_dwordx4 v8, s[48:51], s65 offen lds
    s_add_u32 m0, s72, 1024
    s_nop 0
    buffer_load_dwordx4 v9, s[48:51], s65 offen lds
    s_add_u32 m0, s72, 2048
    s_nop 0
    buffer_load_dwordx4 v8, s[48:51], s66 offen lds
    s_add_u32 m0, s72, 3072
    s_nop 0
    buffer_load_dwordx4 v9, s[48:51], s66 offen lds
    s_add_u32 m0, s72, 4096
    s_nop 0
    buffer_load_dwordx4 v8, s[48:51], s67 offen lds
    s_add_u32 m0, s72, 5120
    s_nop 0
    buffer_load_dwordx4 v9, s[48:51], s67 offen lds
    s_add_u32 s73, s73, 28672
    s_cmp_ge_u32 s73, 143360
    s_cselect_b32 s73, 0, s73
    s_setpc_b64 s[30:31]
LB_i1:
    s_call_b64 s[30:31], LB_issue
    s_mul_i32 s8, s79, 6
    s_sub_u32 s8, s4, s8
    s_lshl_b32 s58, s3, 2
    s_add_u32 s58, s58, s79
    s_mul_i32 s59, s8, 96
    s_lshl_b32 s76, s79, 1
    s_add_u32 s76, s76, s5
    s_bfe_u32 s77, s76, 0x10002
    s_and_b32 s76, s76, 3
    s_load_dword s6, s[38:39], 0
    s_mov_b32 s40, s38
    s_and_b32 s41, s39, 0xffff
    s_mov_b32 s42, 14680064
    s_mov_b32 s43, 0x20000
    v_min_u32 v11, 47, v0
    s_mul_i32 s8, s57, 48
    v_add_u32 v10, s8, v11
    v_lshlrev_b32 v10, 4, v10
    s_mul_i32 s75, s56, 9216
    s_add_u32 s75, s75, 65536
    v_mul_u32_u24 v12, 144, v11
    v_mul_u32_u24 v14, 48, v11
    v_add_u32 v14, 143360, v14
    v_lshlrev_b32 v13, 3, v11
    v_add_u32 v13, 147456, v13
    s_call_b64 s[30:31], LB_setup
    s_waitcnt vmcnt(14)
    s_barrier
    s_call_b64 s[30:31], LB_issue
    s_waitcnt vmcnt(14)
    s_barrier
    s_call_b64 s[30:31], LB_issue
    s_waitcnt vmcnt(14)
    s_barrier
    s_call_b64 s[30:31], LB_issue
    s_waitcnt vmcnt(14)
    s_barrier
    s_call_b64 s[30:31], LB_issue
    s_waitcnt vmcnt(14)
    s_barrier
    s_call_b64 s[30:31], LB_issue
    s_waitcnt vmcnt(14)
    s_barrier
    s_call_b64 s[30:31], LB_issue
    s_waitcnt vmcnt(14)
    s_barrier
    s_call_b64 s[30:31], LB_issue
    s_waitcnt vmcnt(14)
    s_barrier
    s_waitcnt vmcnt(0)
    s_barrier
    s_call_b64 s[30:31], LB_c1
    ds_read_b64 v[24:25], v14 offset:32
    ds_read_b64 v[26:27], v14 offset:16
    s_waitcnt lgkmcnt(0)
    s_mul_i32 s6, s6, 0x9E3779B1
    s_add_u32 s6, s6, 0x7F4A7C15
    s_barrier
    s_mov_b32 exec_hi, 0xffff
    s_cmp_eq_u32 s78, 0
    s_cbranch_scc0 LBl_pfx
    ds_read_b128 v[64:67], v12 offset:6912
    ds_read_b128 v[68:71], v12 offset:6928
    ds_read_b128 v[72:75], v12 offset:6944
    ds_read_b128 v[76:79], v12 offset:6960
    ds_read_b128 v[80:83], v12 offset:6976
    ds_read_b128 v[84:87], v12 offset:6992
    ds_read_b128 v[88:91], v12 offset:7008
    ds_read_b128 v[92:95], v12 offset:7024
    v_mov_b32 v57, s6
    v_mov_b32 v59, s6
    s_waitcnt lgkmcnt(4)
    v_pk_add_f32 v[64:65], v[64:65], v[72:73]
    v_pk_add_f32 v[66:67], v[66:67], v[74:75]
    v_pk_add_f32 v[68:69], v[68:69], v[76:77]
    v_pk_add_f32 v[70:71], v[70:71], v[78:79]
    v_pk_add_f32 v[64:65], v[64:65], v[68:69]
    v_pk_add_f32 v[66:67], v[66:67], v[70:71]
    v_pk_add_f32 v[64:65], v[64:65], v[66:67]
    v_add_f32 v56, v64, v65
    s_waitcnt lgkmcnt(0)
    v_pk_add_f32 v[80:81], v[80:81], v[88:89]
    v_pk_add_f32 v[82:83], v[82:83], v[90:91]
    v_pk_add_f32 v[84:85], v[84:85], v[92:93]
    v_pk_add_f32 v[86:87], v[86:87], v[94:95]
    v_pk_add_f32 v[80:81], v[80:81], v[84:85]
    v_pk_add_f32 v[82:83], v[82:83], v[86:87]
    v_pk_add_f32 v[80:81], v[80:81], v[82:83]
    v_add_f32 v58, v80, v81
    buffer_store_dwordx4 v[56:59], v10, s[40:43], s75 offen sc0 sc1
    s_branch LBl_x2
LBl_pfx:
    ds_read_b128 v[64:67], v12 offset:0
    ds_read_b128 v[68:71], v12 offset:16
    ds_read_b128 v[72:75], v12 offset:32
    ds_read_b128 v[76:79], v12 offset:48
    ds_read_b128 v[80:83], v12 offset:64
    ds_read_b128 v[84:87], v12 offset:80
    ds_read_b128 v[88:91], v12 offset:96
    ds_read_b128 v[92:95], v12 offset:112
    v_mov_b32 v60, 0
    v_mov_b32 v61, 0
    ds_write_b64 v13, v[60:61]
    s_waitcnt lgkmcnt(1)
    v_mul_f32 v30, v26, v64
    v_mul_f32 v31, v26, v65
    v_fma_f32 v30, -v27, v65, v30
    v_fma_f32 v31, v27, v64, v31
    ds_write_b64 v13, v[30:31] offset:384
    v_fma_f32 v16, v24, v64, v66
    v_fma_f32 v17, v24, v65, v67
    v_fma_f32 v16, -v25, v65, v16
    v_fma_f32 v17, v25, v64, v17
    v_mul_f32 v32, v26, v16
    v_mul_f32 v33, v26, v17
    v_fma_f32 v32, -v27, v17, v32
    v_fma_f32 v33, v27, v16, v33
    ds_write_b64 v13, v[32:33] offset:768
    v_fma_f32 v18, v24, v16, v68
    v_fma_f32 v19, v24, v17, v69
    v_fma_f32 v18, -v25, v17, v18
    v_fma_f32 v19, v25, v16, v19
    v_mul_f32 v34, v26, v18
    v_mul_f32 v35, v26, v19
    v_fma_f32 v34, -v27, v19, v34
    v_fma_f32 v35, v27, v18, v35
    ds_write_b64 v13, v[34:35] offset:1152
    v_fma_f32 v16, v24, v18, v70
    v_fma_f32 v17, v24, v19, v71
    v_fma_f32 v16, -v25, v19, v16
    v_fma_f32 v17, v25, v18, v17
    v_mul_f32 v28, v26, v16
    v_mul_f32 v29, v26, v17
    v_fma_f32 v28, -v27, v17, v28
    v_fma_f32 v29, v27, v16, v29
    ds_write_b64 v13, v[28:29] offset:1536
    v_fma_f32 v18, v24, v16, v72
    v_fma_f32 v19, v24, v17, v73
    v_fma_f32 v18, -v25, v17, v18
    v_fma_f32 v19, v25, v16, v19
    v_mul_f32 v30, v26, v18
    v_mul_f32 v31, v26, v19
    v_fma_f32 v30, -v27, v19, v30
    v_fma_f32 v31, v27, v18, v31
    ds_write_b64 v13, v[30:31] offset:1920
    v_fma_f32 v16, v24, v18, v74
    v_fma_f32 v17, v24, v19, v75
    v_fma_f32 v16, -v25, v19, v16
    v_fma_f32 v17, v25, v18, v17
    v_mul_f32 v32, v26, v16
    v_mul_f32 v33, v26, v17
    v_fma_f32 v32, -v27, v17, v32
    v_fma_f32 v33, v27, v16, v33
    ds_write_b64 v13, v[32:33] offset:2304
    v_fma_f32 v18, v24, v16, v76
    v_fma_f32 v19, v24, v17, v77
    v_fma_f32 v18, -v25, v17, v18
    v_fma_f32 v19, v25, v16, v19
    v_mul_f32 v34, v26, v18
    v_mul_f32 v35, v26, v19
    v_fma_f32 v34, -v27, v19, v34
    v_fma_f32 v35, v27, v18, v35
    ds_write_b64 v13, v[34:35] offset:2688
    v_fma_f32 v16, v24, v18, v78
    v_fma_f32 v17, v24, v19, v79
    v_fma_f32 v16, -v25, v19, v16
    v_fma_f32 v17, v25, v18, v17
    v_mul_f32 v28, v26, v16
    v_mul_f32 v29, v26, v17
    v_fma_f32 v28, -v27, v17, v28
    v_fma_f32 v29, v27, v16, v29
    ds_write_b64 v13, v[28:29] offset:3072
    v_fma_f32 v18, v24, v16, v80
    v_fma_f32 v19, v24, v17, v81
    v_fma_f32 v18, -v25, v17, v18
    v_fma_f32 v19, v25, v16, v19
    v_mul_f32 v30, v26, v18
    v_mul_f32 v31, v26, v19
    v_fma_f32 v30, -v27, v19, v30
    v_fma_f32 v31, v27, v18, v31
    ds_write_b64 v13, v[30:31] offset:3456
    v_fma_f32 v16, v24, v18, v82
    v_fma_f32 v17, v24, v19, v83
    v_fma_f32 v16, -v25, v19, v16
    v_fma_f32 v17, v25, v18, v17
    v_mul_f32 v32, v26, v16
    v_mul_f32 v33, v26, v17
    v_fma_f32 v32, -v27, v17, v32
    v_fma_f32 v33, v27, v16, v33
    ds_write_b64 v13, v[32:33] offset:3840
    v_fma_f32 v18, v24, v16, v84
    v_fma_f32 v19, v24, v17, v85
    v_fma_f32 v18, -v25, v17, v18
    v_fma_f32 v19, v25, v16, v19
    v_mul_f32 v34, v26, v18
    v_mul_f32 v35, v26, v19
    v_fma_f32 v34, -v27, v19, v34
    v_fma_f32 v35, v27, v18, v35
    ds_write_b64 v13, v[34:35] offset:4224
    v_fma_f32 v16, v24, v18, v86
    v_fma_f32 v17, v24, v19, v87
    v_fma_f32 v16, -v25, v19, v16
    v_fma_f32 v17, v25, v18, v17
    v_mul_f32 v28, v26, v16
    v_mul_f32 v29, v26, v17
    v_fma_f32 v28, -v27, v17, v28
    v_fma_f32 v29, v27, v16, v29
    ds_write_b64 v13, v[28:29] offset:4608
    v_fma_f32 v18, v24, v16, v88
    v_fma_f32 v19, v24, v17, v89
    v_fma_f32 v18, -v25, v17, v18
    v_fma_f32 v19, v25, v16, v19
    v_mul_f32 v30, v26, v18
    v_mul_f32 v31, v26, v19
    v_fma_f32 v30, -v27, v19, v30
    v_fma_f32 v31, v27, v18, v31
    ds_write_b64 v13, v[30:31] offset:4992
    v_fma_f32 v16, v24, v18, v90
    v_fma_f32 v17, v24, v19, v91
    v_fma_f32 v16, -v25, v19, v16
    v_fma_f32 v17, v25, v18, v17
    v_mul_f32 v32, v26, v16
    v_mul_f32 v33, v26, v17
    v_fma_f32 v32, -v27, v17, v32
    v_fma_f32 v33, v27, v16, v33
    ds_write_b64 v13, v[32:33] offset:5376
    v_fma_f32 v18, v24, v16, v92
    v_fma_f32 v19, v24, v17, v93
    v_fma_f32 v18, -v25, v17, v18
    v_fma_f32 v19, v25, v16, v19
    v_mul_f32 v34, v26, v18
    v_mul_f32 v35, v26, v19
    v_fma_f32 v34, -v27, v19, v34
    v_fma_f32 v35, v27, v18, v35
    ds_write_b64 v13, v[34:35] offset:5760
LBl_x2:
    s_mov_b64 exec, -1
    s_call_b64 s[30:31], LB_c2
    s_call_b64 s[30:31], LB_c3
    s_waitcnt lgkmcnt(0)
    s_barrier
    s_branch LB2
LB_const:
    s_sub_u32 s78, s5, 6
    s_mul_i32 s71, s57, 48
    v_min_u32 v11, 47, v0
    v_add_u32 v14, s71, v11
    v_lshlrev_b32 v15, 1, v14
    v_mul_u32_u24 v2, 48, v11
    v_add_u32 v2, 143360, v2
    v_and_b32 v3, 15, v0
    v_mul_u32_u24 v3, 48, v3
    v_add_u32 v3, 143360, v3
    s_waitcnt lgkmcnt(0)
    global_load_ushort v16, v15, s[18:19]
    global_load_ushort v17, v15, s[20:21]
    global_load_ushort v18, v15, s[30:31]
    s_load_dword s6, s[38:39], 0
    s_mul_i32 s8, s79, 6
    s_sub_u32 s8, s4, s8
    s_lshl_b32 s58, s3, 2
    s_add_u32 s58, s58, s79
    s_mul_i32 s59, s8, 96
    s_lshl_b32 s76, s79, 1
    s_add_u32 s76, s76, s5
    s_bfe_u32 s77, s76, 0x10002
    s_and_b32 s76, s76, 3
    s_mov_b32 s40, s38
    s_and_b32 s41, s39, 0xffff
    s_mov_b32 s42, 14680064
    s_mov_b32 s43, 0x20000
    v_lshrrev_b32 v4, 4, v0
    s_lshl_b32 s70, s78, 3
    v_add_u32 v4, s70, v4
    v_lshlrev_b32 v4, 3, v4
    v_cvt_f32_u32 v4, v4
    v_sub_f32 v5, 0x42f00000, v4
    v_add_f32 v6, 0x42000000, v4
    v_sub_f32 v7, 0x42f00000, v6
    s_mul_i32 s70, s78, 6144
    s_add_u32 s70, s70, 145664
    v_lshl_add_u32 v8, v0, 4, s70
    v_lshlrev_b32 v10, 4, v14
    s_mul_i32 s61, s78, 9216
    s_add_u32 s61, s61, 65536
    s_lshl_b32 s70, s78, 3
    s_add_u32 s70, s70, 153600
    v_lshl_add_u32 v11, v11, 4, s70
    v_mov_b32 v12, 4.0
    v_mov_b32 v13, 0x41000000
    s_call_b64 s[30:31], LB_setup
    s_waitcnt vmcnt(0)
    v_lshlrev_b32 v19, 16, v18
    v_mul_f32 v19, 0x3fb8aa3b, v19
    v_exp_f32 v19, v19
    s_nop 0
    v_cvt_pk_bf16_f32 v19, v19, v19
    v_lshlrev_b32 v19, 16, v19
    v_lshlrev_b32 v16, 16, v16
    v_lshlrev_b32 v17, 16, v17
    v_mul_f32 v26, v19, v16
    v_mul_f32 v27, v19, v17
    v_mul_f32 v26, 0x3fb8aa3b, v26
    v_mul_f32 v27, 0x3e22f983, v27
    v_exp_f32 v80, v26
    v_fract_f32 v81, v27
    v_cos_f32 v20, v81
    v_sin_f32 v21, v81
    s_nop 0
    v_mul_f32 v20, v80, v20
    v_mul_f32 v21, v80, v21
    v_mul_f32 v80, v16, v16
    v_fmac_f32 v80, v17, v17
    v_rcp_f32 v80, v80
    v_add_f32 v81, -1.0, v20
    v_mul_f32 v24, v81, v16
    v_fmac_f32 v24, v21, v17
    v_mul_f32 v25, v21, v16
    v_fma_f32 v25, -v81, v17, v25
    v_add_f32 v80, v80, v80
    v_mul_f32 v24, v80, v24
    v_mul_f32 v25, v80, v25
    ds_write_b128 v2, v[24:27] offset:16
    ds_read_b128 v[84:87], v3 offset:16
    ds_read_b128 v[88:91], v3 offset:784
    ds_read_b128 v[92:95], v3 offset:1552
    v_mul_f32 v80, v12, v26
    v_mul_f32 v81, v12, v27
    v_exp_f32 v80, v80
    v_fract_f32 v81, v81
    v_cos_f32 v22, v81
    v_sin_f32 v23, v81
    s_nop 0
    v_mul_f32 v22, v80, v22
    v_mul_f32 v23, v80, v23
    v_mul_f32 v80, v13, v26
    v_mul_f32 v81, v13, v27
    v_exp_f32 v80, v80
    v_fract_f32 v81, v81
    v_cos_f32 v28, v81
    v_sin_f32 v29, v81
    s_nop 0
    v_mul_f32 v28, v80, v28
    v_mul_f32 v29, v80, v29
    ds_write_b128 v2, v[20:23]
    ds_write_b64 v2, v[28:29] offset:32
    s_waitcnt lgkmcnt(0)
    s_mul_i32 s6, s6, 0x9E3779B1
    s_add_u32 s6, s6, 0x7F4A7C15
    v_mul_f32 v80, v5, v86
    v_mul_f32 v81, v5, v87
    v_exp_f32 v80, v80
    v_fract_f32 v81, v81
    v_cos_f32 v110, v81
    v_sin_f32 v111, v81
    s_nop 0
    v_mul_f32 v110, v80, v110
    v_mul_f32 v111, v80, v111
    v_mul_f32 v80, v4, v86
    v_mul_f32 v81, v4, v87
    v_exp_f32 v80, v80
    v_fract_f32 v81, v81
    v_cos_f32 v82, v81
    v_sin_f32 v83, v81
    s_nop 0
    v_mul_f32 v82, v80, v82
    v_mul_f32 v83, v80, v83
    v_mul_f32 v112, v84, v82
    v_mul_f32 v113, v84, v83
    v_fma_f32 v112, -v85, v83, v112
    v_fma_f32 v113, v85, v82, v113
    ds_write_b128 v8, v[110:113] offset:0
    v_mul_f32 v80, v5, v90
    v_mul_f32 v81, v5, v91
    v_exp_f32 v80, v80
    v_fract_f32 v81, v81
    v_cos_f32 v114, v81
    v_sin_f32 v115, v81
    s_nop 0
    v_mul_f32 v114, v80, v114
    v_mul_f32 v115, v80, v115
    v_mul_f32 v80, v4, v90
    v_mul_f32 v81, v4, v91
    v_exp_f32 v80, v80
    v_fract_f32 v81, v81
    v_cos_f32 v82, v81
    v_sin_f32 v83, v81
    s_nop 0
    v_mul_f32 v82, v80, v82
    v_mul_f32 v83, v80, v83
    v_mul_f32 v116, v88, v82
    v_mul_f32 v117, v88, v83
    v_fma_f32 v116, -v89, v83, v116
    v_fma_f32 v117, v89, v82, v117
    ds_write_b128 v8, v[114:117] offset:1024
    v_mul_f32 v80, v5, v94
    v_mul_f32 v81, v5, v95
    v_exp_f32 v80, v80
    v_fract_f32 v81, v81
    v_cos_f32 v110, v81
    v_sin_f32 v111, v81
    s_nop 0
    v_mul_f32 v110, v80, v110
    v_mul_f32 v111, v80, v111
    v_mul_f32 v80, v4, v94
    v_mul_f32 v81, v4, v95
    v_exp_f32 v80, v80
    v_fract_f32 v81, v81
    v_cos_f32 v82, v81
    v_sin_f32 v83, v81
    s_nop 0
    v_mul_f32 v82, v80, v82
    v_mul_f32 v83, v80, v83
    v_mul_f32 v112, v92, v82
    v_mul_f32 v113, v92, v83
    v_fma_f32 v112, -v93, v83, v112
    v_fma_f32 v113, v93, v82, v113
    ds_write_b128 v8, v[110:113] offset:2048
    v_mul_f32 v80, v7, v86
    v_mul_f32 v81, v7, v87
    v_exp_f32 v80, v80
    v_fract_f32 v81, v81
    v_cos_f32 v114, v81
    v_sin_f32 v115, v81
    s_nop 0
    v_mul_f32 v114, v80, v114
    v_mul_f32 v115, v80, v115
    v_mul_f32 v80, v6, v86
    v_mul_f32 v81, v6, v87
    v_exp_f32 v80, v80
    v_fract_f32 v81, v81
    v_cos_f32 v82, v81
    v_sin_f32 v83, v81
    s_nop 0
    v_mul_f32 v82, v80, v82
    v_mul_f32 v83, v80, v83
    v_mul_f32 v116, v84, v82
    v_mul_f32 v117, v84, v83
    v_fma_f32 v116, -v85, v83, v116
    v_fma_f32 v117, v85, v82, v117
    ds_write_b128 v8, v[114:117] offset:3072
    v_mul_f32 v80, v7, v90
    v_mul_f32 v81, v7, v91
    v_exp_f32 v80, v80
    v_fract_f32 v81, v81
    v_cos_f32 v110, v81
    v_sin_f32 v111, v81
    s_nop 0
    v_mul_f32 v110, v80, v110
    v_mul_f32 v111, v80, v111
    v_mul_f32 v80, v6, v90
    v_mul_f32 v81, v6, v91
    v_exp_f32 v80, v80
    v_fract_f32 v81, v81
    v_cos_f32 v82, v81
    v_sin_f32 v83, v81
    s_nop 0
    v_mul_f32 v82, v80, v82
    v_mul_f32 v83, v80, v83
    v_mul_f32 v112, v88, v82
    v_mul_f32 v113, v88, v83
    v_fma_f32 v112, -v89, v83, v112
    v_fma_f32 v113, v89, v82, v113
    ds_write_b128 v8, v[110:113] offset:4096
    v_mul_f32 v80, v7, v94
    v_mul_f32 v81, v7, v95
    v_exp_f32 v80, v80
    v_fract_f32 v81, v81
    v_cos_f32 v114, v81
    v_sin_f32 v115, v81
    s_nop 0
    v_mul_f32 v114, v80, v114
    v_mul_f32 v115, v80, v115
    v_mul_f32 v80, v6, v94
    v_mul_f32 v81, v6, v95
    v_exp_f32 v80, v80
    v_fract_f32 v81, v81
    v_cos_f32 v82, v81
    v_sin_f32 v83, v81
    s_nop 0
    v_mul_f32 v82, v80, v82
    v_mul_f32 v83, v80, v83
    v_mul_f32 v116, v92, v82
    v_mul_f32 v117, v92, v83
    v_fma_f32 v116, -v93, v83, v116
    v_fma_f32 v117, v93, v82, v117
    ds_write_b128 v8, v[114:117] offset:5120
    s_setprio 3
    s_barrier
    s_sub_i32 s70, s56, s78
    s_sub_i32 s70, s70, 1
    s_max_i32 s70, s70, 0
    s_lshl_b32 s70, s70, 7
    v_cvt_f32_u32 v12, s70
    v_mul_f32 v80, v12, v26
    v_mul_f32 v81, v12, v27
    v_exp_f32 v80, v80
    v_fract_f32 v81, v81
    v_cos_f32 v32, v81
    v_sin_f32 v33, v81
    s_nop 0
    v_mul_f32 v32, v80, v32
    v_mul_f32 v33, v80, v33
    s_sub_i32 s70, s56, s78
    s_sub_i32 s70, s70, 3
    s_max_i32 s70, s70, 0
    s_lshl_b32 s70, s70, 7
    v_cvt_f32_u32 v12, s70
    v_mul_f32 v80, v12, v26
    v_mul_f32 v81, v12, v27
    v_exp_f32 v80, v80
    v_fract_f32 v81, v81
    v_cos_f32 v34, v81
    v_sin_f32 v35, v81
    s_nop 0
    v_mul_f32 v34, v80, v34
    v_mul_f32 v35, v80, v35
    s_barrier
    s_sub_i32 s70, s56, s78
    s_sub_i32 s70, s70, 5
    s_max_i32 s70, s70, 0
    s_lshl_b32 s70, s70, 7
    v_cvt_f32_u32 v12, s70
    v_mul_f32 v80, v12, v26
    v_mul_f32 v81, v12, v27
    v_exp_f32 v80, v80
    v_fract_f32 v81, v81
    v_cos_f32 v36, v81
    v_sin_f32 v37, v81
    s_nop 0
    v_mul_f32 v36, v80, v36
    v_mul_f32 v37, v80, v37
    s_sub_i32 s70, s56, s78
    s_sub_i32 s70, s70, 7
    s_max_i32 s70, s70, 0
    s_lshl_b32 s70, s70, 7
    v_cvt_f32_u32 v12, s70
    v_mul_f32 v80, v12, v26
    v_mul_f32 v81, v12, v27
    v_exp_f32 v80, v80
    v_fract_f32 v81, v81
    v_cos_f32 v38, v81
    v_sin_f32 v39, v81
    s_nop 0
    v_mul_f32 v38, v80, v38
    v_mul_f32 v39, v80, v39
    s_barrier
    s_sub_i32 s70, s56, s78
    s_sub_i32 s70, s70, 9
    s_max_i32 s70, s70, 0
    s_lshl_b32 s70, s70, 7
    v_cvt_f32_u32 v12, s70
    v_mul_f32 v80, v12, v26
    v_mul_f32 v81, v12, v27
    v_exp_f32 v80, v80
    v_fract_f32 v81, v81
    v_cos_f32 v40, v81
    v_sin_f32 v41, v81
    s_nop 0
    v_mul_f32 v40, v80, v40
    v_mul_f32 v41, v80, v41
    s_sub_i32 s70, s56, s78
    s_sub_i32 s70, s70, 11
    s_max_i32 s70, s70, 0
    s_lshl_b32 s70, s70, 7
    v_cvt_f32_u32 v12, s70
    v_mul_f32 v80, v12, v26
    v_mul_f32 v81, v12, v27
    v_exp_f32 v80, v80
    v_fract_f32 v81, v81
    v_cos_f32 v42, v81
    v_sin_f32 v43, v81
    s_nop 0
    v_mul_f32 v42, v80, v42
    v_mul_f32 v43, v80, v43
    s_barrier
    s_sub_i32 s70, s56, s78
    s_sub_i32 s70, s70, 13
    s_max_i32 s70, s70, 0
    s_lshl_b32 s70, s70, 7
    v_cvt_f32_u32 v12, s70
    v_mul_f32 v80, v12, v26
    v_mul_f32 v81, v12, v27
    v_exp_f32 v80, v80
    v_fract_f32 v81, v81
    v_cos_f32 v44, v81
    v_sin_f32 v45, v81
    s_nop 0
    v_mul_f32 v44, v80, v44
    v_mul_f32 v45, v80, v45
    s_sub_i32 s70, s56, s78
    s_sub_i32 s70, s70, 15
    s_max_i32 s70, s70, 0
    s_lshl_b32 s70, s70, 7
    v_cvt_f32_u32 v12, s70
    v_mul_f32 v80, v12, v26
    v_mul_f32 v81, v12, v27
    v_exp_f32 v80, v80
    v_fract_f32 v81, v81
    v_cos_f32 v46, v81
    v_sin_f32 v47, v81
    s_nop 0
    v_mul_f32 v46, v80, v46
    v_mul_f32 v47, v80, v47
    s_barrier
    v_mov_b32 v48, 0
    v_mov_b32 v49, s6
    v_mov_b32 v50, 0
    v_mov_b32 v51, s6
    v_mov_b32 v52, 0
    v_mov_b32 v53, s6
    v_mov_b32 v54, 0
    v_mov_b32 v55, s6
    v_mov_b32 v56, 0
    v_mov_b32 v57, s6
    v_mov_b32 v58, 0
    v_mov_b32 v59, s6
    v_mov_b32 v60, 0
    v_mov_b32 v61, s6
    v_mov_b32 v62, 0
    v_mov_b32 v63, s6
    v_mov_b32 v64, 0
    v_mov_b32 v65, s6
    v_mov_b32 v66, 0
    v_mov_b32 v67, s6
    v_mov_b32 v68, 0
    v_mov_b32 v69, s6
    v_mov_b32 v70, 0
    v_mov_b32 v71, s6
    v_mov_b32 v72, 0
    v_mov_b32 v73, s6
    v_mov_b32 v74, 0
    v_mov_b32 v75, s6
    v_mov_b32 v76, 0
    v_mov_b32 v77, s6
    v_mov_b32 v78, 0
    v_mov_b32 v79, s6
    s_barrier
    s_barrier
    s_barrier
    s_waitcnt lgkmcnt(0)
    s_barrier
    s_setprio 0
    s_barrier
    s_mov_b32 s71, 0
LBh_poll:
    s_mov_b32 s72, s61
    s_add_u32 s70, s78, 0
    s_cmp_lt_u32 s70, s56
    s_cbranch_scc0 LBh_issued
    buffer_load_dwordx4 v[48:51], v10, s[40:43], s72 offen sc0 sc1
    s_add_u32 s72, s72, 18432
    s_add_u32 s70, s78, 2
    s_cmp_lt_u32 s70, s56
    s_cbranch_scc0 LBh_issued
    buffer_load_dwordx4 v[52:55], v10, s[40:43], s72 offen sc0 sc1
    s_add_u32 s72, s72, 18432
    s_add_u32 s70, s78, 4
    s_cmp_lt_u32 s70, s56
    s_cbranch_scc0 LBh_issued
    buffer_load_dwordx4 v[56:59], v10, s[40:43], s72 offen sc0 sc1
    s_add_u32 s72, s72, 18432
    s_add_u32 s70, s78, 6
    s_cmp_lt_u32 s70, s56
    s_cbranch_scc0 LBh_issued
    buffer_load_dwordx4 v[60:63], v10, s[40:43], s72 offen sc0 sc1
    s_add_u32 s72, s72, 18432
    s_add_u32 s70, s78, 8
    s_cmp_lt_u32 s70, s56
    s_cbranch_scc0 LBh_issued
    buffer_load_dwordx4 v[64:67], v10, s[40:43], s72 offen sc0 sc1
    s_add_u32 s72, s72, 18432
    s_add_u32 s70, s78, 10
    s_cmp_lt_u32 s70, s56
    s_cbranch_scc0 LBh_issued
    buffer_load_dwordx4 v[68:71], v10, s[40:43], s72 offen sc0 sc1
    s_add_u32 s72, s72, 18432
    s_add_u32 s70, s78, 12
    s_cmp_lt_u32 s70, s56
    s_cbranch_scc0 LBh_issued
    buffer_load_dwordx4 v[72:75], v10, s[40:43], s72 offen sc0 sc1
    s_add_u32 s72, s72, 18432
    s_add_u32 s70, s78, 14
    s_cmp_lt_u32 s70, s56
    s_cbranch_scc0 LBh_issued
    buffer_load_dwordx4 v[76:79], v10, s[40:43], s72 offen sc0 sc1
LBh_issued:
    s_waitcnt vmcnt(0)
    v_xor_b32 v80, s6, v49
    v_xor_b32 v81, s6, v51
    v_xor_b32 v82, s6, v53
    v_xor_b32 v83, s6, v55
    v_or3_b32 v80, v80, v82, v83
    v_xor_b32 v82, s6, v57
    v_xor_b32 v83, s6, v59
    v_or3_b32 v80, v80, v82, v83
    v_xor_b32 v82, s6, v61
    v_xor_b32 v83, s6, v63
    v_or3_b32 v80, v80, v82, v83
    v_xor_b32 v82, s6, v65
    v_xor_b32 v83, s6, v67
    v_or3_b32 v80, v80, v82, v83
    v_xor_b32 v82, s6, v69
    v_xor_b32 v83, s6, v71
    v_or3_b32 v80, v80, v82, v83
    v_xor_b32 v82, s6, v73
    v_xor_b32 v83, s6, v75
    v_or3_b32 v80, v80, v82, v83
    v_xor_b32 v82, s6, v77
    v_xor_b32 v83, s6, v79
    v_or3_b32 v80, v80, v82, v83
    v_or_b32 v80, v80, v81
    v_cmp_ne_u32 vcc, 0, v80
    s_add_u32 s71, s71, 1
    s_cmp_ge_u32 s71, 40000
    s_cbranch_scc1 LBh_got
    s_cbranch_vccz LBh_got
    s_sleep 6
    s_branch LBh_poll
LBh_got:
    v_mul_f32 v84, v32, v48
    v_mul_f32 v85, v32, v50
    v_fma_f32 v84, -v33, v50, v84
    v_fmac_f32 v85, v33, v48
    v_fmac_f32 v84, v34, v52
    v_fmac_f32 v85, v34, v54
    v_fma_f32 v84, -v35, v54, v84
    v_fmac_f32 v85, v35, v52
    v_fmac_f32 v84, v36, v56
    v_fmac_f32 v85, v36, v58
    v_fma_f32 v84, -v37, v58, v84
    v_fmac_f32 v85, v37, v56
    v_fmac_f32 v84, v38, v60
    v_fmac_f32 v85, v38, v62
    v_fma_f32 v84, -v39, v62, v84
    v_fmac_f32 v85, v39, v60
    v_mul_f32 v86, v40, v64
    v_mul_f32 v87, v40, v66
    v_fma_f32 v86, -v41, v66, v86
    v_fmac_f32 v87, v41, v64
    v_fmac_f32 v86, v42, v68
    v_fmac_f32 v87, v42, v70
    v_fma_f32 v86, -v43, v70, v86
    v_fmac_f32 v87, v43, v68
    v_fmac_f32 v86, v44, v72
    v_fmac_f32 v87, v44, v74
    v_fma_f32 v86, -v45, v74, v86
    v_fmac_f32 v87, v45, v72
    v_fmac_f32 v86, v46, v76
    v_fmac_f32 v87, v46, v78
    v_fma_f32 v86, -v47, v78, v86
    v_fmac_f32 v87, v47, v76
    v_pk_add_f32 v[84:85], v[84:85], v[86:87]
    ds_write_b64 v11, v[84:85]
    s_waitcnt lgkmcnt(0)
    s_barrier
    s_branch LB2_late
LB_compute:
    v_and_b32 v6, 15, v0
    v_lshrrev_b32 v7, 4, v0
    v_bfe_u32 v9, v0, 1, 3
    v_xor_b32 v9, v9, v7
    v_lshlrev_b32 v9, 4, v9
    v_lshl_add_u32 v4, v6, 7, v9
    v_xor_b32 v5, 64, v4
    s_lshl_b32 s70, s5, 12
    v_add_u32 v2, s70, v4
    v_add_u32 v3, s70, v5
    s_lshl_b32 s70, s5, 2
    v_add_u32 v10, s70, v7
    s_mul_i32 s8, s79, 6
    s_sub_u32 s8, s4, s8
    s_lshl_b32 s58, s3, 2
    s_add_u32 s58, s58, s79
    s_mul_i32 s59, s8, 96
    s_lshl_b32 s76, s79, 1
    s_add_u32 s76, s76, s5
    s_bfe_u32 s77, s76, 0x10002
    s_and_b32 s76, s76, 3
    s_waitcnt lgkmcnt(0)
    s_load_dword s6, s[38:39], 0
    s_mov_b32 s40, s38
    s_and_b32 s41, s39, 0xffff
    s_mov_b32 s42, 14680064
    s_mov_b32 s43, 0x20000
    v_mul_u32_u24 v15, 144, v6
    v_lshl_add_u32 v1, v10, 2, v15
    v_add_u32 v1, 6912, v1
    v_lshl_add_u32 v15, v10, 3, v15
    v_mul_u32_u24 v11, 48, v6
    v_add_u32 v11, 143360, v11
    s_mul_i32 s70, s5, 3072
    s_add_u32 s70, s70, 145664
    v_lshl_add_u32 v12, v0, 4, s70
    v_mul_u32_u24 v13, 384, v10
    v_lshl_add_u32 v13, v6, 3, v13
    v_add_u32 v13, 147456, v13
    v_lshlrev_b32 v14, 4, v6
    v_add_u32 v14, 153600, v14
    v_and_b32 v8, 1, v7
    v_lshlrev_b32 v8, 2, v8
    v_xor_b32 v8, v8, v0
    v_lshlrev_b32 v8, 4, v8
    s_lshl_b32 s61, s56, 2
    s_add_u32 s61, s61, s5
    s_mul_i32 s61, s61, 73728
    s_mul_i32 s62, s57, 3072
    s_add_u32 s61, s61, s62
    s_add_u32 s61, s61, 1048576
    s_add_u32 s62, s61, 36864
    s_lshl_b32 s63, s56, 1
    s_lshr_b32 s64, s5, 1
    s_add_u32 s63, s63, s64
    s_lshl_b32 s63, s63, 5
    s_lshl_b32 s64, s57, 1
    s_add_u32 s63, s63, s64
    s_and_b32 s64, s5, 1
    s_add_u32 s63, s63, s64
    s_lshl_b32 s63, s63, 7
    s_add_u32 s63, s63, 524288
    v_mov_b32 v16, 0
    v_mov_b32 v17, 0
    v_mov_b32 v18, 0
    v_mov_b32 v19, 0
    v_mov_b32 v20, 0
    v_mov_b32 v21, 0
    v_mov_b32 v22, 0
    v_mov_b32 v23, 0
    v_mov_b32 v24, 0
    v_mov_b32 v25, 0
    v_mov_b32 v26, 0
    v_mov_b32 v27, 0
    v_mov_b32 v28, 0
    v_mov_b32 v29, 0
    v_mov_b32 v30, 0
    v_mov_b32 v31, 0
    v_mov_b32 v32, 0
    v_mov_b32 v33, 0
    v_mov_b32 v34, 0
    v_mov_b32 v35, 0
    v_mov_b32 v36, 0
    v_mov_b32 v37, 0
    v_mov_b32 v38, 0
    v_mov_b32 v39, 0
    v_mov_b32 v40, 0
    v_mov_b32 v41, 0
    v_mov_b32 v42, 0
    v_mov_b32 v43, 0
    v_mov_b32 v44, 0
    v_mov_b32 v45, 0
    v_mov_b32 v46, 0
    v_mov_b32 v47, 0
    v_mov_b32 v48, 0
    v_mov_b32 v49, 0
    v_mov_b32 v50, 0
    v_mov_b32 v51, 0
    v_mov_b32 v52, 0
    v_mov_b32 v53, 0
    v_mov_b32 v54, 0
    v_mov_b32 v55, 0
    v_mov_b32 v56, 0
    v_mov_b32 v57, 0
    v_mov_b32 v58, 0
    v_mov_b32 v59, 0
    v_mov_b32 v60, 0
    v_mov_b32 v61, 0
    v_mov_b32 v62, 0
    v_mov_b32 v63, 0
    s_call_b64 s[30:31], LB_setup
    s_mov_b32 s78, 0
    s_mov_b32 s71, 0xfffe4000
    s_waitcnt lgkmcnt(0)
    s_mul_i32 s6, s6, 0x9E3779B1
    s_add_u32 s6, s6, 0x7F4A7C15
    s_barrier
    ds_read_b128 v[146:149], v2 offset:0
    ds_read_b128 v[154:157], v4 offset:16384
    ds_read_b128 v[158:161], v4 offset:18432
    ds_read_b128 v[162:165], v4 offset:20480
    ds_read_b128 v[166:169], v4 offset:22528
    ds_read_b128 v[170:173], v4 offset:24576
    ds_read_b128 v[174:177], v4 offset:26624
    ds_read_b128 v[150:153], v2 offset:2048
    .p2align 3
LBc_loop:
    s_waitcnt lgkmcnt(6)
    v_mfma_f32_16x16x32_bf16 v[16:19], v[146:149], v[154:157], v[16:19]
    ds_read_b128 v[178:181], v3 offset:0
    s_waitcnt lgkmcnt(6)
    v_mfma_f32_16x16x32_bf16 v[20:23], v[146:149], v[158:161], v[20:23]
    ds_read_b128 v[186:189], v5 offset:16384
    s_waitcnt lgkmcnt(6)
    v_mfma_f32_16x16x32_bf16 v[24:27], v[146:149], v[162:165], v[24:27]
    s_add_u32 s78, s78, 1
    s_cmp_eq_u32 s78, 5
    s_cselect_b32 s70, s71, 28672
    s_waitcnt lgkmcnt(5)
    v_mfma_f32_16x16x32_bf16 v[28:31], v[146:149], v[166:169], v[28:31]
    ds_read_b128 v[190:193], v5 offset:18432
    s_waitcnt lgkmcnt(5)
    v_mfma_f32_16x16x32_bf16 v[32:35], v[146:149], v[170:173], v[32:35]
    ds_read_b128 v[194:197], v5 offset:20480
    s_waitcnt lgkmcnt(5)
    v_mfma_f32_16x16x32_bf16 v[36:39], v[146:149], v[174:177], v[36:39]
    v_add_u32 v2, s70, v2
    s_waitcnt lgkmcnt(4)
    v_mfma_f32_16x16x32_bf16 v[40:43], v[150:153], v[154:157], v[40:43]
    ds_read_b128 v[198:201], v5 offset:22528
    v_mfma_f32_16x16x32_bf16 v[44:47], v[150:153], v[158:161], v[44:47]
    ds_read_b128 v[202:205], v5 offset:24576
    v_mfma_f32_16x16x32_bf16 v[48:51], v[150:153], v[162:165], v[48:51]
    v_add_u32 v4, s70, v4
    s_cmp_eq_u32 s78, 9
    v_mfma_f32_16x16x32_bf16 v[52:55], v[150:153], v[166:169], v[52:55]
    ds_read_b128 v[206:209], v5 offset:26624
    v_mfma_f32_16x16x32_bf16 v[56:59], v[150:153], v[170:173], v[56:59]
    ds_read_b128 v[182:185], v3 offset:2048
    v_mfma_f32_16x16x32_bf16 v[60:63], v[150:153], v[174:177], v[60:63]
    s_cbranch_scc1 LBc_last
    s_barrier
    s_waitcnt lgkmcnt(6)
    v_mfma_f32_16x16x32_bf16 v[16:19], v[178:181], v[186:189], v[16:19]
    ds_read_b128 v[146:149], v2 offset:0
    s_waitcnt lgkmcnt(6)
    v_mfma_f32_16x16x32_bf16 v[20:23], v[178:181], v[190:193], v[20:23]
    ds_read_b128 v[154:157], v4 offset:16384
    s_waitcnt lgkmcnt(6)
    v_mfma_f32_16x16x32_bf16 v[24:27], v[178:181], v[194:197], v[24:27]
    v_add_u32 v3, s70, v3
    s_waitcnt lgkmcnt(5)
    v_mfma_f32_16x16x32_bf16 v[28:31], v[178:181], v[198:201], v[28:31]
    ds_read_b128 v[158:161], v4 offset:18432
    s_waitcnt lgkmcnt(5)
    v_mfma_f32_16x16x32_bf16 v[32:35], v[178:181], v[202:205], v[32:35]
    ds_read_b128 v[162:165], v4 offset:20480
    s_waitcnt lgkmcnt(5)
    v_mfma_f32_16x16x32_bf16 v[36:39], v[178:181], v[206:209], v[36:39]
    v_add_u32 v5, s70, v5
    s_waitcnt lgkmcnt(4)
    v_mfma_f32_16x16x32_bf16 v[40:43], v[182:185], v[186:189], v[40:43]
    ds_read_b128 v[166:169], v4 offset:22528
    v_mfma_f32_16x16x32_bf16 v[44:47], v[182:185], v[190:193], v[44:47]
    ds_read_b128 v[170:173], v4 offset:24576
    v_mfma_f32_16x16x32_bf16 v[48:51], v[182:185], v[194:197], v[48:51]
    v_mfma_f32_16x16x32_bf16 v[52:55], v[182:185], v[198:201], v[52:55]
    ds_read_b128 v[174:177], v4 offset:26624
    v_mfma_f32_16x16x32_bf16 v[56:59], v[182:185], v[202:205], v[56:59]
    ds_read_b128 v[150:153], v2 offset:2048
    v_mfma_f32_16x16x32_bf16 v[60:63], v[182:185], v[206:209], v[60:63]
    s_branch LBc_loop
LBc_last:
    s_waitcnt lgkmcnt(6)
    v_mfma_f32_16x16x32_bf16 v[16:19], v[178:181], v[186:189], v[16:19]
    ds_read_b128 v[64:67], v11 offset:0
    s_waitcnt lgkmcnt(6)
    v_mfma_f32_16x16x32_bf16 v[20:23], v[178:181], v[190:193], v[20:23]
    ds_read_b128 v[68:71], v12 offset:0
    s_waitcnt lgkmcnt(6)
    v_mfma_f32_16x16x32_bf16 v[24:27], v[178:181], v[194:197], v[24:27]
    s_waitcnt lgkmcnt(5)
    v_mfma_f32_16x16x32_bf16 v[28:31], v[178:181], v[198:201], v[28:31]
    ds_read_b64 v[72:73], v11 offset:16
    s_waitcnt lgkmcnt(5)
    v_mfma_f32_16x16x32_bf16 v[32:35], v[178:181], v[202:205], v[32:35]
    ds_read_b128 v[74:77], v11 offset:768
    s_waitcnt lgkmcnt(5)
    v_mfma_f32_16x16x32_bf16 v[36:39], v[178:181], v[206:209], v[36:39]
    s_waitcnt lgkmcnt(4)
    v_mfma_f32_16x16x32_bf16 v[40:43], v[182:185], v[186:189], v[40:43]
    ds_read_b128 v[78:81], v12 offset:1024
    v_mfma_f32_16x16x32_bf16 v[44:47], v[182:185], v[190:193], v[44:47]
    ds_read_b64 v[82:83], v11 offset:784
    v_mfma_f32_16x16x32_bf16 v[48:51], v[182:185], v[194:197], v[48:51]
    v_mfma_f32_16x16x32_bf16 v[52:55], v[182:185], v[198:201], v[52:55]
    ds_read_b128 v[84:87], v11 offset:1536
    v_mfma_f32_16x16x32_bf16 v[56:59], v[182:185], v[202:205], v[56:59]
    ds_read_b128 v[88:91], v12 offset:2048
    v_mfma_f32_16x16x32_bf16 v[60:63], v[182:185], v[206:209], v[60:63]
    ds_read_b64 v[92:93], v11 offset:1552
    s_nop 6
    s_waitcnt lgkmcnt(0)
    .p2align 3
    v_pk_fma_f32 v[210:211], v[16:17], v[64:65], v[18:19] op_sel:[0,0,0] op_sel_hi:[1,0,1]
    v_pk_fma_f32 v[212:213], v[28:29], v[64:65], v[30:31] op_sel:[0,0,0] op_sel_hi:[1,0,1]
    v_pk_fma_f32 v[210:211], v[28:29], v[64:65], v[210:211] op_sel:[0,1,0] op_sel_hi:[1,1,1] neg_lo:[0,1,0] neg_hi:[0,1,0]
    v_pk_fma_f32 v[212:213], v[16:17], v[64:65], v[212:213] op_sel:[0,1,0] op_sel_hi:[1,1,1]
    v_pk_fma_f32 v[218:219], v[20:21], v[74:75], v[22:23] op_sel:[0,0,0] op_sel_hi:[1,0,1]
    v_pk_fma_f32 v[220:221], v[32:33], v[74:75], v[34:35] op_sel:[0,0,0] op_sel_hi:[1,0,1]
    v_pk_fma_f32 v[218:219], v[32:33], v[74:75], v[218:219] op_sel:[0,1,0] op_sel_hi:[1,1,1] neg_lo:[0,1,0] neg_hi:[0,1,0]
    v_pk_fma_f32 v[220:221], v[20:21], v[74:75], v[220:221] op_sel:[0,1,0] op_sel_hi:[1,1,1]
    v_pk_fma_f32 v[226:227], v[24:25], v[84:85], v[26:27] op_sel:[0,0,0] op_sel_hi:[1,0,1]
    v_pk_fma_f32 v[228:229], v[36:37], v[84:85], v[38:39] op_sel:[0,0,0] op_sel_hi:[1,0,1]
    v_pk_fma_f32 v[226:227], v[36:37], v[84:85], v[226:227] op_sel:[0,1,0] op_sel_hi:[1,1,1] neg_lo:[0,1,0] neg_hi:[0,1,0]
    v_pk_fma_f32 v[228:229], v[24:25], v[84:85], v[228:229] op_sel:[0,1,0] op_sel_hi:[1,1,1]
    v_pk_fma_f32 v[214:215], v[210:211], v[64:65], v[40:41] op_sel:[0,0,0] op_sel_hi:[1,0,1]
    v_pk_fma_f32 v[216:217], v[212:213], v[64:65], v[52:53] op_sel:[0,0,0] op_sel_hi:[1,0,1]
    v_pk_fma_f32 v[214:215], v[212:213], v[64:65], v[214:215] op_sel:[0,1,0] op_sel_hi:[1,1,1] neg_lo:[0,1,0] neg_hi:[0,1,0]
    v_pk_fma_f32 v[216:217], v[210:211], v[64:65], v[216:217] op_sel:[0,1,0] op_sel_hi:[1,1,1]
    v_pk_fma_f32 v[222:223], v[218:219], v[74:75], v[44:45] op_sel:[0,0,0] op_sel_hi:[1,0,1]
    v_pk_fma_f32 v[224:225], v[220:221], v[74:75], v[56:57] op_sel:[0,0,0] op_sel_hi:[1,0,1]
    v_pk_fma_f32 v[222:223], v[220:221], v[74:75], v[222:223] op_sel:[0,1,0] op_sel_hi:[1,1,1] neg_lo:[0,1,0] neg_hi:[0,1,0]
    v_pk_fma_f32 v[224:225], v[218:219], v[74:75], v[224:225] op_sel:[0,1,0] op_sel_hi:[1,1,1]
    v_pk_fma_f32 v[230:231], v[226:227], v[84:85], v[48:49] op_sel:[0,0,0] op_sel_hi:[1,0,1]
    v_pk_fma_f32 v[232:233], v[228:229], v[84:85], v[60:61] op_sel:[0,0,0] op_sel_hi:[1,0,1]
    v_pk_fma_f32 v[230:231], v[228:229], v[84:85], v[230:231] op_sel:[0,1,0] op_sel_hi:[1,1,1] neg_lo:[0,1,0] neg_hi:[0,1,0]
    v_pk_fma_f32 v[232:233], v[226:227], v[84:85], v[232:233] op_sel:[0,1,0] op_sel_hi:[1,1,1]
    v_pk_fma_f32 v[210:211], v[214:215], v[64:65], v[42:43] op_sel:[0,0,0] op_sel_hi:[1,0,1]
    v_pk_fma_f32 v[212:213], v[216:217], v[64:65], v[54:55] op_sel:[0,0,0] op_sel_hi:[1,0,1]
    v_pk_fma_f32 v[210:211], v[216:217], v[64:65], v[210:211] op_sel:[0,1,0] op_sel_hi:[1,1,1] neg_lo:[0,1,0] neg_hi:[0,1,0]
    v_pk_fma_f32 v[212:213], v[214:215], v[64:65], v[212:213] op_sel:[0,1,0] op_sel_hi:[1,1,1]
    v_pk_fma_f32 v[218:219], v[222:223], v[74:75], v[46:47] op_sel:[0,0,0] op_sel_hi:[1,0,1]
    v_pk_fma_f32 v[220:221], v[224:225], v[74:75], v[58:59] op_sel:[0,0,0] op_sel_hi:[1,0,1]
    v_pk_fma_f32 v[218:219], v[224:225], v[74:75], v[218:219] op_sel:[0,1,0] op_sel_hi:[1,1,1] neg_lo:[0,1,0] neg_hi:[0,1,0]
    v_pk_fma_f32 v[220:221], v[222:223], v[74:75], v[220:221] op_sel:[0,1,0] op_sel_hi:[1,1,1]
    v_pk_fma_f32 v[226:227], v[230:231], v[84:85], v[50:51] op_sel:[0,0,0] op_sel_hi:[1,0,1]
    v_pk_fma_f32 v[228:229], v[232:233], v[84:85], v[62:63] op_sel:[0,0,0] op_sel_hi:[1,0,1]
    v_pk_fma_f32 v[226:227], v[232:233], v[84:85], v[226:227] op_sel:[0,1,0] op_sel_hi:[1,1,1] neg_lo:[0,1,0] neg_hi:[0,1,0]
    v_pk_fma_f32 v[228:229], v[230:231], v[84:85], v[228:229] op_sel:[0,1,0] op_sel_hi:[1,1,1]
    v_fma_f32 v234, v66, v210, v211
    v_fma_f32 v235, v66, v212, v213
    v_fma_f32 v236, v76, v218, v219
    v_fma_f32 v237, v76, v220, v221
    v_fma_f32 v238, v86, v226, v227
    v_fma_f32 v239, v86, v228, v229
    v_fma_f32 v234, -v67, v212, v234
    v_fma_f32 v235, v67, v210, v235
    v_fma_f32 v236, -v77, v220, v236
    v_fma_f32 v237, v77, v218, v237
    v_fma_f32 v238, -v87, v228, v238
    v_fma_f32 v239, v87, v226, v239
    v_mul_f32_e64 v240, v68, v234
    v_mul_f32_e64 v241, v68, v235
    v_mul_f32_e64 v242, v78, v236
    v_mul_f32_e64 v243, v78, v237
    v_mul_f32_e64 v244, v88, v238
    v_mul_f32_e64 v245, v88, v239
    v_fma_f32 v240, -v69, v235, v240
    v_fma_f32 v241, v69, v234, v241
    ds_write_b32 v1, v240 offset:0
    ds_write_b32 v1, v241 offset:64
    v_fma_f32 v242, -v79, v237, v242
    v_fma_f32 v243, v79, v236, v243
    ds_write_b32 v1, v242 offset:2304
    ds_write_b32 v1, v243 offset:2368
    v_fma_f32 v244, -v89, v239, v244
    v_fma_f32 v245, v89, v238, v245
    ds_write_b32 v1, v244 offset:4608
    ds_write_b32 v1, v245 offset:4672
    ds_write_b64 v15, v[234:235] offset:0
    ds_write_b64 v15, v[236:237] offset:2304
    ds_write_b64 v15, v[238:239] offset:4608
    s_waitcnt lgkmcnt(0)
    s_barrier
    .p2align 3
    v_pk_mul_f32 v[246:247], v[28:29], v[72:73] op_sel:[0,1] op_sel_hi:[1,1] neg_lo:[0,1] neg_hi:[0,1]
    v_pk_mul_f32 v[28:29], v[28:29], v[72:73] op_sel:[0,0] op_sel_hi:[1,0]
    v_pk_fma_f32 v[28:29], v[16:17], v[72:73], v[28:29] op_sel:[0,1,0] op_sel_hi:[1,1,1]
    v_pk_fma_f32 v[16:17], v[16:17], v[72:73], v[246:247] op_sel:[0,0,0] op_sel_hi:[1,0,1]
    v_pk_mul_f32 v[248:249], v[30:31], v[72:73] op_sel:[0,1] op_sel_hi:[1,1] neg_lo:[0,1] neg_hi:[0,1]
    v_pk_mul_f32 v[30:31], v[30:31], v[72:73] op_sel:[0,0] op_sel_hi:[1,0]
    v_pk_fma_f32 v[30:31], v[18:19], v[72:73], v[30:31] op_sel:[0,1,0] op_sel_hi:[1,1,1]
    v_pk_fma_f32 v[18:19], v[18:19], v[72:73], v[248:249] op_sel:[0,0,0] op_sel_hi:[1,0,1]
    v_pk_mul_f32 v[246:247], v[52:53], v[72:73] op_sel:[0,1] op_sel_hi:[1,1] neg_lo:[0,1] neg_hi:[0,1]
    v_pk_mul_f32 v[52:53], v[52:53], v[72:73] op_sel:[0,0] op_sel_hi:[1,0]
    v_pk_fma_f32 v[52:53], v[40:41], v[72:73], v[52:53] op_sel:[0,1,0] op_sel_hi:[1,1,1]
    v_pk_fma_f32 v[40:41], v[40:41], v[72:73], v[246:247] op_sel:[0,0,0] op_sel_hi:[1,0,1]
    v_pk_mul_f32 v[248:249], v[54:55], v[72:73] op_sel:[0,1] op_sel_hi:[1,1] neg_lo:[0,1] neg_hi:[0,1]
    v_pk_mul_f32 v[54:55], v[54:55], v[72:73] op_sel:[0,0] op_sel_hi:[1,0]
    v_pk_fma_f32 v[54:55], v[42:43], v[72:73], v[54:55] op_sel:[0,1,0] op_sel_hi:[1,1,1]
    v_pk_fma_f32 v[42:43], v[42:43], v[72:73], v[248:249] op_sel:[0,0,0] op_sel_hi:[1,0,1]
    v_pk_mul_f32 v[246:247], v[32:33], v[82:83] op_sel:[0,1] op_sel_hi:[1,1] neg_lo:[0,1] neg_hi:[0,1]
    v_pk_mul_f32 v[32:33], v[32:33], v[82:83] op_sel:[0,0] op_sel_hi:[1,0]
    v_pk_fma_f32 v[32:33], v[20:21], v[82:83], v[32:33] op_sel:[0,1,0] op_sel_hi:[1,1,1]
    v_pk_fma_f32 v[20:21], v[20:21], v[82:83], v[246:247] op_sel:[0,0,0] op_sel_hi:[1,0,1]
    v_pk_mul_f32 v[248:249], v[34:35], v[82:83] op_sel:[0,1] op_sel_hi:[1,1] neg_lo:[0,1] neg_hi:[0,1]
    v_pk_mul_f32 v[34:35], v[34:35], v[82:83] op_sel:[0,0] op_sel_hi:[1,0]
    v_pk_fma_f32 v[34:35], v[22:23], v[82:83], v[34:35] op_sel:[0,1,0] op_sel_hi:[1,1,1]
    v_pk_fma_f32 v[22:23], v[22:23], v[82:83], v[248:249] op_sel:[0,0,0] op_sel_hi:[1,0,1]
    v_pk_mul_f32 v[246:247], v[56:57], v[82:83] op_sel:[0,1] op_sel_hi:[1,1] neg_lo:[0,1] neg_hi:[0,1]
    v_pk_mul_f32 v[56:57], v[56:57], v[82:83] op_sel:[0,0] op_sel_hi:[1,0]
    v_pk_fma_f32 v[56:57], v[44:45], v[82:83], v[56:57] op_sel:[0,1,0] op_sel_hi:[1,1,1]
    v_pk_fma_f32 v[44:45], v[44:45], v[82:83], v[246:247] op_sel:[0,0,0] op_sel_hi:[1,0,1]
    v_pk_mul_f32 v[248:249], v[58:59], v[82:83] op_sel:[0,1] op_sel_hi:[1,1] neg_lo:[0,1] neg_hi:[0,1]
    v_pk_mul_f32 v[58:59], v[58:59], v[82:83] op_sel:[0,0] op_sel_hi:[1,0]
    v_pk_fma_f32 v[58:59], v[46:47], v[82:83], v[58:59] op_sel:[0,1,0] op_sel_hi:[1,1,1]
    v_pk_fma_f32 v[46:47], v[46:47], v[82:83], v[248:249] op_sel:[0,0,0] op_sel_hi:[1,0,1]
    v_pk_mul_f32 v[246:247], v[36:37], v[92:93] op_sel:[0,1] op_sel_hi:[1,1] neg_lo:[0,1] neg_hi:[0,1]
    v_pk_mul_f32 v[36:37], v[36:37], v[92:93] op_sel:[0,0] op_sel_hi:[1,0]
    v_pk_fma_f32 v[36:37], v[24:25], v[92:93], v[36:37] op_sel:[0,1,0] op_sel_hi:[1,1,1]
    v_pk_fma_f32 v[24:25], v[24:25], v[92:93], v[246:247] op_sel:[0,0,0] op_sel_hi:[1,0,1]
    v_pk_mul_f32 v[248:249], v[38:39], v[92:93] op_sel:[0,1] op_sel_hi:[1,1] neg_lo:[0,1] neg_hi:[0,1]
    v_pk_mul_f32 v[38:39], v[38:39], v[92:93] op_sel:[0,0] op_sel_hi:[1,0]
    v_pk_fma_f32 v[38:39], v[26:27], v[92:93], v[38:39] op_sel:[0,1,0] op_sel_hi:[1,1,1]
    v_pk_fma_f32 v[26:27], v[26:27], v[92:93], v[248:249] op_sel:[0,0,0] op_sel_hi:[1,0,1]
    v_pk_mul_f32 v[246:247], v[60:61], v[92:93] op_sel:[0,1] op_sel_hi:[1,1] neg_lo:[0,1] neg_hi:[0,1]
    v_pk_mul_f32 v[60:61], v[60:61], v[92:93] op_sel:[0,0] op_sel_hi:[1,0]
    v_pk_fma_f32 v[60:61], v[48:49], v[92:93], v[60:61] op_sel:[0,1,0] op_sel_hi:[1,1,1]
    v_pk_fma_f32 v[48:49], v[48:49], v[92:93], v[246:247] op_sel:[0,0,0] op_sel_hi:[1,0,1]
    v_pk_mul_f32 v[248:249], v[62:63], v[92:93] op_sel:[0,1] op_sel_hi:[1,1] neg_lo:[0,1] neg_hi:[0,1]
    v_pk_mul_f32 v[62:63], v[62:63], v[92:93] op_sel:[0,0] op_sel_hi:[1,0]
    v_pk_fma_f32 v[62:63], v[50:51], v[92:93], v[62:63] op_sel:[0,1,0] op_sel_hi:[1,1,1]
    v_pk_fma_f32 v[50:51], v[50:51], v[92:93], v[248:249] op_sel:[0,0,0] op_sel_hi:[1,0,1]
    v_mul_f32 v234, v72, v210
    v_mul_f32 v235, v72, v212
    v_fma_f32 v234, -v73, v212, v234
    v_fma_f32 v235, v73, v210, v235
    v_mul_f32 v236, v82, v218
    v_mul_f32 v237, v82, v220
    v_fma_f32 v236, -v83, v220, v236
    v_fma_f32 v237, v83, v218, v237
    v_mul_f32 v238, v92, v226
    v_mul_f32 v239, v92, v228
    v_fma_f32 v238, -v93, v228, v238
    v_fma_f32 v239, v93, v226, v239
    v_min_u32 v1, 47, v0
    v_cmp_lt_u32 vcc, 23, v1
    v_lshlrev_b32 v1, 7, v1
    v_mov_b32 v2, 33792
    v_cndmask_b32 v2, 0, v2, vcc
    v_add_u32 v1, v1, v2
    v_mov_b32 v2, s6
    v_mov_b32 v3, 0
    s_barrier
    ds_read_b128 v[218:221], v14 offset:0
    ds_read_b64 v[240:241], v13 offset:0
    ds_read_b128 v[222:225], v14 offset:256
    ds_read_b64 v[242:243], v13 offset:128
    ds_read_b128 v[226:229], v14 offset:512
    ds_read_b64 v[244:245], v13 offset:256
    s_waitcnt lgkmcnt(0)
    .p2align 3
    v_pk_add_f32 v[218:219], v[218:219], v[220:221]
    v_fma_f32 v230, v70, v218, v240
    v_fma_f32 v232, v70, v219, v241
    v_fma_f32 v230, -v71, v219, v230
    v_fma_f32 v232, v71, v218, v232
    v_fma_f32 v231, v66, v230, v234
    v_fma_f32 v233, v66, v232, v235
    v_fma_f32 v231, -v67, v232, v231
    v_fma_f32 v233, v67, v230, v233
    v_pk_fma_f32 v[16:17], v[230:231], v[64:65], v[16:17] op_sel:[0,0,0] op_sel_hi:[1,0,1]
    v_pk_fma_f32 v[28:29], v[232:233], v[64:65], v[28:29] op_sel:[0,0,0] op_sel_hi:[1,0,1]
    v_pk_fma_f32 v[16:17], v[232:233], v[64:65], v[16:17] op_sel:[0,1,0] op_sel_hi:[1,1,1] neg_lo:[0,1,0] neg_hi:[0,1,0]
    v_pk_fma_f32 v[28:29], v[230:231], v[64:65], v[28:29] op_sel:[0,1,0] op_sel_hi:[1,1,1]
    v_pk_fma_f32 v[18:19], v[16:17], v[64:65], v[18:19] op_sel:[0,0,0] op_sel_hi:[1,0,1]
    v_pk_fma_f32 v[30:31], v[28:29], v[64:65], v[30:31] op_sel:[0,0,0] op_sel_hi:[1,0,1]
    v_pk_fma_f32 v[18:19], v[28:29], v[64:65], v[18:19] op_sel:[0,1,0] op_sel_hi:[1,1,1] neg_lo:[0,1,0] neg_hi:[0,1,0]
    v_pk_fma_f32 v[30:31], v[16:17], v[64:65], v[30:31] op_sel:[0,1,0] op_sel_hi:[1,1,1]
    v_pk_fma_f32 v[40:41], v[18:19], v[64:65], v[40:41] op_sel:[0,0,0] op_sel_hi:[1,0,1]
    v_pk_fma_f32 v[52:53], v[30:31], v[64:65], v[52:53] op_sel:[0,0,0] op_sel_hi:[1,0,1]
    v_pk_fma_f32 v[40:41], v[30:31], v[64:65], v[40:41] op_sel:[0,1,0] op_sel_hi:[1,1,1] neg_lo:[0,1,0] neg_hi:[0,1,0]
    v_pk_fma_f32 v[52:53], v[18:19], v[64:65], v[52:53] op_sel:[0,1,0] op_sel_hi:[1,1,1]
    v_pk_fma_f32 v[42:43], v[40:41], v[64:65], v[42:43] op_sel:[0,0,0] op_sel_hi:[1,0,1]
    v_pk_fma_f32 v[54:55], v[52:53], v[64:65], v[54:55] op_sel:[0,0,0] op_sel_hi:[1,0,1]
    v_pk_fma_f32 v[42:43], v[52:53], v[64:65], v[42:43] op_sel:[0,1,0] op_sel_hi:[1,1,1] neg_lo:[0,1,0] neg_hi:[0,1,0]
    v_pk_fma_f32 v[54:55], v[40:41], v[64:65], v[54:55] op_sel:[0,1,0] op_sel_hi:[1,1,1]
    v_cvt_pk_bf16_f32 v246, v16, v17
    v_cvt_pk_bf16_f32 v247, v18, v19
    v_cvt_pk_bf16_f32 v248, v40, v41
    v_cvt_pk_bf16_f32 v249, v42, v43
    buffer_store_dwordx4 v[246:249], v8, s[40:43], s61 offen offset:0 sc0 sc1
    v_cvt_pk_bf16_f32 v250, -v28, -v29
    v_cvt_pk_bf16_f32 v251, -v30, -v31
    v_cvt_pk_bf16_f32 v252, -v52, -v53
    v_cvt_pk_bf16_f32 v253, -v54, -v55
    buffer_store_dwordx4 v[250:253], v8, s[40:43], s62 offen offset:0 sc0 sc1
    v_pk_add_f32 v[222:223], v[222:223], v[224:225]
    v_fma_f32 v230, v80, v222, v242
    v_fma_f32 v232, v80, v223, v243
    v_fma_f32 v230, -v81, v223, v230
    v_fma_f32 v232, v81, v222, v232
    v_fma_f32 v231, v76, v230, v236
    v_fma_f32 v233, v76, v232, v237
    v_fma_f32 v231, -v77, v232, v231
    v_fma_f32 v233, v77, v230, v233
    v_pk_fma_f32 v[20:21], v[230:231], v[74:75], v[20:21] op_sel:[0,0,0] op_sel_hi:[1,0,1]
    v_pk_fma_f32 v[32:33], v[232:233], v[74:75], v[32:33] op_sel:[0,0,0] op_sel_hi:[1,0,1]
    v_pk_fma_f32 v[20:21], v[232:233], v[74:75], v[20:21] op_sel:[0,1,0] op_sel_hi:[1,1,1] neg_lo:[0,1,0] neg_hi:[0,1,0]
    v_pk_fma_f32 v[32:33], v[230:231], v[74:75], v[32:33] op_sel:[0,1,0] op_sel_hi:[1,1,1]
    v_pk_fma_f32 v[22:23], v[20:21], v[74:75], v[22:23] op_sel:[0,0,0] op_sel_hi:[1,0,1]
    v_pk_fma_f32 v[34:35], v[32:33], v[74:75], v[34:35] op_sel:[0,0,0] op_sel_hi:[1,0,1]
    v_pk_fma_f32 v[22:23], v[32:33], v[74:75], v[22:23] op_sel:[0,1,0] op_sel_hi:[1,1,1] neg_lo:[0,1,0] neg_hi:[0,1,0]
    v_pk_fma_f32 v[34:35], v[20:21], v[74:75], v[34:35] op_sel:[0,1,0] op_sel_hi:[1,1,1]
    v_pk_fma_f32 v[44:45], v[22:23], v[74:75], v[44:45] op_sel:[0,0,0] op_sel_hi:[1,0,1]
    v_pk_fma_f32 v[56:57], v[34:35], v[74:75], v[56:57] op_sel:[0,0,0] op_sel_hi:[1,0,1]
    v_pk_fma_f32 v[44:45], v[34:35], v[74:75], v[44:45] op_sel:[0,1,0] op_sel_hi:[1,1,1] neg_lo:[0,1,0] neg_hi:[0,1,0]
    v_pk_fma_f32 v[56:57], v[22:23], v[74:75], v[56:57] op_sel:[0,1,0] op_sel_hi:[1,1,1]
    v_pk_fma_f32 v[46:47], v[44:45], v[74:75], v[46:47] op_sel:[0,0,0] op_sel_hi:[1,0,1]
    v_pk_fma_f32 v[58:59], v[56:57], v[74:75], v[58:59] op_sel:[0,0,0] op_sel_hi:[1,0,1]
    v_pk_fma_f32 v[46:47], v[56:57], v[74:75], v[46:47] op_sel:[0,1,0] op_sel_hi:[1,1,1] neg_lo:[0,1,0] neg_hi:[0,1,0]
    v_pk_fma_f32 v[58:59], v[44:45], v[74:75], v[58:59] op_sel:[0,1,0] op_sel_hi:[1,1,1]
    v_cvt_pk_bf16_f32 v218, v20, v21
    v_cvt_pk_bf16_f32 v219, v22, v23
    v_cvt_pk_bf16_f32 v220, v44, v45
    v_cvt_pk_bf16_f32 v221, v46, v47
    buffer_store_dwordx4 v[218:221], v8, s[40:43], s61 offen offset:1024 sc0 sc1
    v_cvt_pk_bf16_f32 v222, -v32, -v33
    v_cvt_pk_bf16_f32 v223, -v34, -v35
    v_cvt_pk_bf16_f32 v224, -v56, -v57
    v_cvt_pk_bf16_f32 v225, -v58, -v59
    buffer_store_dwordx4 v[222:225], v8, s[40:43], s62 offen offset:1024 sc0 sc1
    v_pk_add_f32 v[226:227], v[226:227], v[228:229]
    v_fma_f32 v230, v90, v226, v244
    v_fma_f32 v232, v90, v227, v245
    v_fma_f32 v230, -v91, v227, v230
    v_fma_f32 v232, v91, v226, v232
    v_fma_f32 v231, v86, v230, v238
    v_fma_f32 v233, v86, v232, v239
    v_fma_f32 v231, -v87, v232, v231
    v_fma_f32 v233, v87, v230, v233
    v_pk_fma_f32 v[24:25], v[230:231], v[84:85], v[24:25] op_sel:[0,0,0] op_sel_hi:[1,0,1]
    v_pk_fma_f32 v[36:37], v[232:233], v[84:85], v[36:37] op_sel:[0,0,0] op_sel_hi:[1,0,1]
    v_pk_fma_f32 v[24:25], v[232:233], v[84:85], v[24:25] op_sel:[0,1,0] op_sel_hi:[1,1,1] neg_lo:[0,1,0] neg_hi:[0,1,0]
    v_pk_fma_f32 v[36:37], v[230:231], v[84:85], v[36:37] op_sel:[0,1,0] op_sel_hi:[1,1,1]
    v_pk_fma_f32 v[26:27], v[24:25], v[84:85], v[26:27] op_sel:[0,0,0] op_sel_hi:[1,0,1]
    v_pk_fma_f32 v[38:39], v[36:37], v[84:85], v[38:39] op_sel:[0,0,0] op_sel_hi:[1,0,1]
    v_pk_fma_f32 v[26:27], v[36:37], v[84:85], v[26:27] op_sel:[0,1,0] op_sel_hi:[1,1,1] neg_lo:[0,1,0] neg_hi:[0,1,0]
    v_pk_fma_f32 v[38:39], v[24:25], v[84:85], v[38:39] op_sel:[0,1,0] op_sel_hi:[1,1,1]
    v_pk_fma_f32 v[48:49], v[26:27], v[84:85], v[48:49] op_sel:[0,0,0] op_sel_hi:[1,0,1]
    v_pk_fma_f32 v[60:61], v[38:39], v[84:85], v[60:61] op_sel:[0,0,0] op_sel_hi:[1,0,1]
    v_pk_fma_f32 v[48:49], v[38:39], v[84:85], v[48:49] op_sel:[0,1,0] op_sel_hi:[1,1,1] neg_lo:[0,1,0] neg_hi:[0,1,0]
    v_pk_fma_f32 v[60:61], v[26:27], v[84:85], v[60:61] op_sel:[0,1,0] op_sel_hi:[1,1,1]
    v_pk_fma_f32 v[50:51], v[48:49], v[84:85], v[50:51] op_sel:[0,0,0] op_sel_hi:[1,0,1]
    v_pk_fma_f32 v[62:63], v[60:61], v[84:85], v[62:63] op_sel:[0,0,0] op_sel_hi:[1,0,1]
    v_pk_fma_f32 v[50:51], v[60:61], v[84:85], v[50:51] op_sel:[0,1,0] op_sel_hi:[1,1,1] neg_lo:[0,1,0] neg_hi:[0,1,0]
    v_pk_fma_f32 v[62:63], v[48:49], v[84:85], v[62:63] op_sel:[0,1,0] op_sel_hi:[1,1,1]
    v_cvt_pk_bf16_f32 v246, v24, v25
    v_cvt_pk_bf16_f32 v247, v26, v27
    v_cvt_pk_bf16_f32 v248, v48, v49
    v_cvt_pk_bf16_f32 v249, v50, v51
    buffer_store_dwordx4 v[246:249], v8, s[40:43], s61 offen offset:2048 sc0 sc1
    v_cvt_pk_bf16_f32 v250, -v36, -v37
    v_cvt_pk_bf16_f32 v251, -v38, -v39
    v_cvt_pk_bf16_f32 v252, -v60, -v61
    v_cvt_pk_bf16_f32 v253, -v62, -v63
    buffer_store_dwordx4 v[250:253], v8, s[40:43], s62 offen offset:2048 sc0 sc1
    s_call_b64 s[30:31], LB_c1a
    s_waitcnt vmcnt(9)
    s_mov_b64 exec, 1
    buffer_store_dword v2, v3, s[40:43], s63 offen sc0 sc1
    s_mov_b64 exec, -1
    s_call_b64 s[30:31], LB_c1b
    s_branch LB2_l2
LB2_late:
    s_call_b64 s[30:31], LB_c1
LB2_l2:
    s_call_b64 s[30:31], LB_c2
LB2_l3:
    s_call_b64 s[30:31], LB_c3
LB2:
    s_cmp_eq_u32 s5, 4
    s_cbranch_scc0 LB2_go
    s_mov_b32 s78, 0
LB2_poll:
    s_sleep 4
    buffer_load_dword v109, v108, s[40:43], s37 offen sc0 sc1
    s_add_u32 s78, s78, 1
    s_waitcnt vmcnt(0)
    v_cmp_ne_u32 vcc, s6, v109
    s_cmp_ge_u32 s78, 40000
    s_cbranch_scc1 LB2_go
    s_cbranch_vccnz LB2_poll
LB2_go:
    s_waitcnt vmcnt(0) lgkmcnt(0)
    s_barrier
    s_waitcnt lgkmcnt(0)
    s_add_u32 m0, s14, 0
    s_add_u32 s74, s15, 0
    buffer_load_dwordx4 v107, s[40:43], s74 offen sc0 sc1 lds
    buffer_load_dwordx4 v107, s[40:43], s74 offen offset:1024 sc0 sc1 lds
    s_add_u32 m0, s14, 2048
    s_add_u32 s74, s15, 2048
    buffer_load_dwordx4 v107, s[40:43], s74 offen sc0 sc1 lds
    buffer_load_dwordx4 v107, s[40:43], s74 offen offset:1024 sc0 sc1 lds
    s_add_u32 m0, s14, 4096
    s_add_u32 s74, s15, 4096
    buffer_load_dwordx4 v107, s[40:43], s74 offen sc0 sc1 lds
    buffer_load_dwordx4 v107, s[40:43], s74 offen offset:1024 sc0 sc1 lds
    s_add_u32 m0, s14, 6144
    s_add_u32 s74, s15, 6144
    buffer_load_dwordx4 v107, s[40:43], s74 offen sc0 sc1 lds
    buffer_load_dwordx4 v107, s[40:43], s74 offen offset:1024 sc0 sc1 lds
    v_lshlrev_b32 v15, v106, v122
    v_and_b32 v15, 0xffff0000, v15
    v_lshlrev_b32 v110, v106, v110
    v_and_b32 v110, 0xffff0000, v110
    v_mul_f32 v110, v15, v110
    v_lshlrev_b32 v111, v106, v111
    v_and_b32 v111, 0xffff0000, v111
    v_mul_f32 v111, v15, v111
    v_lshlrev_b32 v112, v106, v112
    v_and_b32 v112, 0xffff0000, v112
    v_mul_f32 v112, v15, v112
    v_lshlrev_b32 v113, v106, v113
    v_and_b32 v113, 0xffff0000, v113
    v_mul_f32 v113, v15, v113
    v_cvt_pk_bf16_f32 v14, v110, v111
    v_lshlrev_b32 v16, 16, v14
    v_and_b32 v17, 0xffff0000, v14
    v_cvt_pk_bf16_f32 v14, v112, v113
    v_lshlrev_b32 v18, 16, v14
    v_and_b32 v19, 0xffff0000, v14
    v_lshlrev_b32 v15, v106, v123
    v_and_b32 v15, 0xffff0000, v15
    v_lshlrev_b32 v114, v106, v114
    v_and_b32 v114, 0xffff0000, v114
    v_mul_f32 v114, v15, v114
    v_lshlrev_b32 v115, v106, v115
    v_and_b32 v115, 0xffff0000, v115
    v_mul_f32 v115, v15, v115
    v_lshlrev_b32 v116, v106, v116
    v_and_b32 v116, 0xffff0000, v116
    v_mul_f32 v116, v15, v116
    v_lshlrev_b32 v117, v106, v117
    v_and_b32 v117, 0xffff0000, v117
    v_mul_f32 v117, v15, v117
    v_cvt_pk_bf16_f32 v14, v114, v115
    v_lshlrev_b32 v32, 16, v14
    v_and_b32 v33, 0xffff0000, v14
    v_cvt_pk_bf16_f32 v14, v116, v117
    v_lshlrev_b32 v34, 16, v14
    v_and_b32 v35, 0xffff0000, v14
    v_lshlrev_b32 v15, v106, v124
    v_and_b32 v15, 0xffff0000, v15
    v_lshlrev_b32 v118, v106, v118
    v_and_b32 v118, 0xffff0000, v118
    v_mul_f32 v118, v15, v118
    v_lshlrev_b32 v119, v106, v119
    v_and_b32 v119, 0xffff0000, v119
    v_mul_f32 v119, v15, v119
    v_lshlrev_b32 v120, v106, v120
    v_and_b32 v120, 0xffff0000, v120
    v_mul_f32 v120, v15, v120
    v_lshlrev_b32 v121, v106, v121
    v_and_b32 v121, 0xffff0000, v121
    v_mul_f32 v121, v15, v121
    v_cvt_pk_bf16_f32 v14, v118, v119
    v_lshlrev_b32 v48, 16, v14
    v_and_b32 v49, 0xffff0000, v14
    v_cvt_pk_bf16_f32 v14, v120, v121
    v_lshlrev_b32 v50, 16, v14
    v_and_b32 v51, 0xffff0000, v14
    s_mov_b32 s44, s34
    s_and_b32 s45, s35, 0xffff
    s_mov_b32 s46, 9437184
    s_mov_b32 s47, 0x20000
    s_mov_b32 s70, 18432
    s_mov_b32 s71, 4608
    s_mov_b32 s72, 23040
    s_waitcnt vmcnt(4)
    s_barrier
    ds_read_b64_tr_b16 v[64:65], v126 offset:0
    ds_read_b64_tr_b16 v[66:67], v127 offset:0
    ds_read_b64_tr_b16 v[68:69], v128 offset:0
    ds_read_b64_tr_b16 v[70:71], v129 offset:0
    ds_read_b64_tr_b16 v[72:73], v130 offset:0
    ds_read_b64_tr_b16 v[74:75], v131 offset:0
    ds_read_b64_tr_b16 v[76:77], v132 offset:0
    ds_read_b64_tr_b16 v[78:79], v133 offset:0
    s_waitcnt lgkmcnt(6)
    v_mfma_f32_16x16x32_bf16 v[16:19], v[64:67], v[146:149], v[16:19]
    ds_read_b64_tr_b16 v[80:81], v126 offset:2048
    v_mfma_f32_16x16x32_bf16 v[32:35], v[64:67], v[182:185], v[32:35]
    ds_read_b64_tr_b16 v[82:83], v127 offset:2048
    v_mfma_f32_16x16x32_bf16 v[48:51], v[64:67], v[218:221], v[48:51]
    s_add_u32 m0, s14, 8192
    s_add_u32 s74, s15, 8192
    buffer_load_dwordx4 v107, s[40:43], s74 offen sc0 sc1 lds
    buffer_load_dwordx4 v107, s[40:43], s74 offen offset:1024 sc0 sc1 lds
    s_waitcnt lgkmcnt(6)
    v_mfma_f32_16x16x32_bf16 v[20:23], v[68:71], v[146:149], 0
    ds_read_b64_tr_b16 v[84:85], v128 offset:2048
    v_mfma_f32_16x16x32_bf16 v[36:39], v[68:71], v[182:185], 0
    ds_read_b64_tr_b16 v[86:87], v129 offset:2048
    v_mfma_f32_16x16x32_bf16 v[52:55], v[68:71], v[218:221], 0
    s_waitcnt lgkmcnt(6)
    v_mfma_f32_16x16x32_bf16 v[24:27], v[72:75], v[146:149], 0
    ds_read_b64_tr_b16 v[88:89], v130 offset:2048
    v_mfma_f32_16x16x32_bf16 v[40:43], v[72:75], v[182:185], 0
    ds_read_b64_tr_b16 v[90:91], v131 offset:2048
    v_mfma_f32_16x16x32_bf16 v[56:59], v[72:75], v[218:221], 0
    s_add_u32 m0, s14, 10240
    s_add_u32 s74, s15, 10240
    buffer_load_dwordx4 v107, s[40:43], s74 offen sc0 sc1 lds
    buffer_load_dwordx4 v107, s[40:43], s74 offen offset:1024 sc0 sc1 lds
    s_waitcnt lgkmcnt(6)
    v_mfma_f32_16x16x32_bf16 v[28:31], v[76:79], v[146:149], 0
    ds_read_b64_tr_b16 v[92:93], v132 offset:2048
    v_mfma_f32_16x16x32_bf16 v[44:47], v[76:79], v[182:185], 0
    ds_read_b64_tr_b16 v[94:95], v133 offset:2048
    v_mfma_f32_16x16x32_bf16 v[60:63], v[76:79], v[218:221], 0
    s_waitcnt vmcnt(4)
    s_barrier
    s_waitcnt lgkmcnt(6)
    v_mfma_f32_16x16x32_bf16 v[16:19], v[80:83], v[150:153], v[16:19]
    ds_read_b64_tr_b16 v[64:65], v126 offset:4096
    v_mfma_f32_16x16x32_bf16 v[32:35], v[80:83], v[186:189], v[32:35]
    ds_read_b64_tr_b16 v[66:67], v127 offset:4096
    v_mfma_f32_16x16x32_bf16 v[48:51], v[80:83], v[222:225], v[48:51]
    s_add_u32 m0, s14, 12288
    s_add_u32 s74, s15, 12288
    buffer_load_dwordx4 v107, s[40:43], s74 offen sc0 sc1 lds
    buffer_load_dwordx4 v107, s[40:43], s74 offen offset:1024 sc0 sc1 lds
    s_waitcnt lgkmcnt(6)
    v_mfma_f32_16x16x32_bf16 v[20:23], v[84:87], v[150:153], v[20:23]
    ds_read_b64_tr_b16 v[68:69], v128 offset:4096
    v_mfma_f32_16x16x32_bf16 v[36:39], v[84:87], v[186:189], v[36:39]
    ds_read_b64_tr_b16 v[70:71], v129 offset:4096
    v_mfma_f32_16x16x32_bf16 v[52:55], v[84:87], v[222:225], v[52:55]
    s_waitcnt lgkmcnt(6)
    v_mfma_f32_16x16x32_bf16 v[24:27], v[88:91], v[150:153], v[24:27]
    ds_read_b64_tr_b16 v[72:73], v130 offset:4096
    v_mfma_f32_16x16x32_bf16 v[40:43], v[88:91], v[186:189], v[40:43]
    ds_read_b64_tr_b16 v[74:75], v131 offset:4096
    v_mfma_f32_16x16x32_bf16 v[56:59], v[88:91], v[222:225], v[56:59]
    s_add_u32 m0, s14, 14336
    s_add_u32 s74, s15, 14336
    buffer_load_dwordx4 v107, s[40:43], s74 offen sc0 sc1 lds
    buffer_load_dwordx4 v107, s[40:43], s74 offen offset:1024 sc0 sc1 lds
    s_waitcnt lgkmcnt(6)
    v_mfma_f32_16x16x32_bf16 v[28:31], v[92:95], v[150:153], v[28:31]
    ds_read_b64_tr_b16 v[76:77], v132 offset:4096
    v_mfma_f32_16x16x32_bf16 v[44:47], v[92:95], v[186:189], v[44:47]
    ds_read_b64_tr_b16 v[78:79], v133 offset:4096
    v_mfma_f32_16x16x32_bf16 v[60:63], v[92:95], v[222:225], v[60:63]
    s_waitcnt lgkmcnt(6)
    v_mfma_f32_16x16x32_bf16 v[16:19], v[64:67], v[154:157], v[16:19]
    ds_read_b64_tr_b16 v[80:81], v126 offset:6144
    v_mfma_f32_16x16x32_bf16 v[32:35], v[64:67], v[190:193], v[32:35]
    ds_read_b64_tr_b16 v[82:83], v127 offset:6144
    v_mfma_f32_16x16x32_bf16 v[48:51], v[64:67], v[226:229], v[48:51]
    s_add_u32 m0, s14, 16384
    s_add_u32 s74, s36, 16384
    buffer_load_dwordx4 v107, s[40:43], s74 offen sc0 sc1 lds
    buffer_load_dwordx4 v107, s[40:43], s74 offen offset:1024 sc0 sc1 lds
    s_waitcnt lgkmcnt(6)
    v_mfma_f32_16x16x32_bf16 v[20:23], v[68:71], v[154:157], v[20:23]
    ds_read_b64_tr_b16 v[84:85], v128 offset:6144
    v_mfma_f32_16x16x32_bf16 v[36:39], v[68:71], v[190:193], v[36:39]
    ds_read_b64_tr_b16 v[86:87], v129 offset:6144
    v_mfma_f32_16x16x32_bf16 v[52:55], v[68:71], v[226:229], v[52:55]
    s_waitcnt lgkmcnt(6)
    v_mfma_f32_16x16x32_bf16 v[24:27], v[72:75], v[154:157], v[24:27]
    ds_read_b64_tr_b16 v[88:89], v130 offset:6144
    v_mfma_f32_16x16x32_bf16 v[40:43], v[72:75], v[190:193], v[40:43]
    ds_read_b64_tr_b16 v[90:91], v131 offset:6144
    v_mfma_f32_16x16x32_bf16 v[56:59], v[72:75], v[226:229], v[56:59]
    s_waitcnt lgkmcnt(6)
    v_mfma_f32_16x16x32_bf16 v[28:31], v[76:79], v[154:157], v[28:31]
    ds_read_b64_tr_b16 v[92:93], v132 offset:6144
    v_mfma_f32_16x16x32_bf16 v[44:47], v[76:79], v[190:193], v[44:47]
    ds_read_b64_tr_b16 v[94:95], v133 offset:6144
    v_mfma_f32_16x16x32_bf16 v[60:63], v[76:79], v[226:229], v[60:63]
    s_waitcnt vmcnt(6)
    s_barrier
    s_waitcnt lgkmcnt(6)
    v_mfma_f32_16x16x32_bf16 v[16:19], v[80:83], v[158:161], v[16:19]
    ds_read_b64_tr_b16 v[64:65], v126 offset:8192
    v_mfma_f32_16x16x32_bf16 v[32:35], v[80:83], v[194:197], v[32:35]
    ds_read_b64_tr_b16 v[66:67], v127 offset:8192
    v_mfma_f32_16x16x32_bf16 v[48:51], v[80:83], v[230:233], v[48:51]
    s_waitcnt lgkmcnt(6)
    v_mfma_f32_16x16x32_bf16 v[20:23], v[84:87], v[158:161], v[20:23]
    ds_read_b64_tr_b16 v[68:69], v128 offset:8192
    v_mfma_f32_16x16x32_bf16 v[36:39], v[84:87], v[194:197], v[36:39]
    ds_read_b64_tr_b16 v[70:71], v129 offset:8192
    v_mfma_f32_16x16x32_bf16 v[52:55], v[84:87], v[230:233], v[52:55]
    s_waitcnt lgkmcnt(6)
    v_mfma_f32_16x16x32_bf16 v[24:27], v[88:91], v[158:161], v[24:27]
    ds_read_b64_tr_b16 v[72:73], v130 offset:8192
    v_mfma_f32_16x16x32_bf16 v[40:43], v[88:91], v[194:197], v[40:43]
    ds_read_b64_tr_b16 v[74:75], v131 offset:8192
    v_mfma_f32_16x16x32_bf16 v[56:59], v[88:91], v[230:233], v[56:59]
    s_waitcnt lgkmcnt(6)
    v_mfma_f32_16x16x32_bf16 v[28:31], v[92:95], v[158:161], v[28:31]
    ds_read_b64_tr_b16 v[76:77], v132 offset:8192
    v_mfma_f32_16x16x32_bf16 v[44:47], v[92:95], v[194:197], v[44:47]
    ds_read_b64_tr_b16 v[78:79], v133 offset:8192
    v_mfma_f32_16x16x32_bf16 v[60:63], v[92:95], v[230:233], v[60:63]
    s_cmp_eq_u32 s5, 4
    s_cbranch_scc0 LB2_m0
    buffer_load_dword v142, v138, s[40:43], 0 offen sc0 sc1
LB2_m0:
    s_waitcnt lgkmcnt(6)
    v_mfma_f32_16x16x32_bf16 v[16:19], v[64:67], v[162:165], v[16:19]
    ds_read_b64_tr_b16 v[80:81], v126 offset:10240
    v_mfma_f32_16x16x32_bf16 v[32:35], v[64:67], v[198:201], v[32:35]
    ds_read_b64_tr_b16 v[82:83], v127 offset:10240
    v_mfma_f32_16x16x32_bf16 v[48:51], v[64:67], v[234:237], v[48:51]
    s_waitcnt lgkmcnt(6)
    v_mfma_f32_16x16x32_bf16 v[20:23], v[68:71], v[162:165], v[20:23]
    ds_read_b64_tr_b16 v[84:85], v128 offset:10240
    v_mfma_f32_16x16x32_bf16 v[36:39], v[68:71], v[198:201], v[36:39]
    ds_read_b64_tr_b16 v[86:87], v129 offset:10240
    v_mfma_f32_16x16x32_bf16 v[52:55], v[68:71], v[234:237], v[52:55]
    s_waitcnt lgkmcnt(6)
    v_mfma_f32_16x16x32_bf16 v[24:27], v[72:75], v[162:165], v[24:27]
    ds_read_b64_tr_b16 v[88:89], v130 offset:10240
    v_mfma_f32_16x16x32_bf16 v[40:43], v[72:75], v[198:201], v[40:43]
    ds_read_b64_tr_b16 v[90:91], v131 offset:10240
    v_mfma_f32_16x16x32_bf16 v[56:59], v[72:75], v[234:237], v[56:59]
    s_waitcnt lgkmcnt(6)
    v_mfma_f32_16x16x32_bf16 v[28:31], v[76:79], v[162:165], v[28:31]
    ds_read_b64_tr_b16 v[92:93], v132 offset:10240
    v_mfma_f32_16x16x32_bf16 v[44:47], v[76:79], v[198:201], v[44:47]
    ds_read_b64_tr_b16 v[94:95], v133 offset:10240
    v_mfma_f32_16x16x32_bf16 v[60:63], v[76:79], v[234:237], v[60:63]
    s_waitcnt vmcnt(0)
    s_cmp_eq_u32 s5, 4
    s_cbranch_scc0 LB2_m2
    s_mov_b32 s78, 0
LB2_m1:
    v_cmp_ne_u32 vcc, s6, v142
    s_add_u32 s78, s78, 1
    s_cmp_ge_u32 s78, 40000
    s_cbranch_scc1 LB2_m2
    s_cbranch_vccz LB2_m2
    s_sleep 4
    buffer_load_dword v142, v138, s[40:43], 0 offen sc0 sc1
    s_waitcnt vmcnt(0)
    s_branch LB2_m1
LB2_m2:
    s_barrier
    s_waitcnt lgkmcnt(6)
    v_mfma_f32_16x16x32_bf16 v[16:19], v[80:83], v[166:169], v[16:19]
    ds_read_b64_tr_b16 v[64:65], v128 offset:12288
    v_mfma_f32_16x16x32_bf16 v[32:35], v[80:83], v[202:205], v[32:35]
    ds_read_b64_tr_b16 v[66:67], v129 offset:12288
    v_mfma_f32_16x16x32_bf16 v[48:51], v[80:83], v[238:241], v[48:51]
    s_waitcnt lgkmcnt(6)
    v_mfma_f32_16x16x32_bf16 v[20:23], v[84:87], v[166:169], v[20:23]
    ds_read_b64_tr_b16 v[68:69], v128 offset:14336
    v_mfma_f32_16x16x32_bf16 v[36:39], v[84:87], v[202:205], v[36:39]
    ds_read_b64_tr_b16 v[70:71], v129 offset:14336
    v_mfma_f32_16x16x32_bf16 v[52:55], v[84:87], v[238:241], v[52:55]
    s_waitcnt lgkmcnt(6)
    v_mfma_f32_16x16x32_bf16 v[24:27], v[88:91], v[166:169], v[24:27]
    ds_read_b64_tr_b16 v[72:73], v128 offset:16384
    v_mfma_f32_16x16x32_bf16 v[40:43], v[88:91], v[202:205], v[40:43]
    ds_read_b64_tr_b16 v[74:75], v129 offset:16384
    v_mfma_f32_16x16x32_bf16 v[56:59], v[88:91], v[238:241], v[56:59]
    s_waitcnt lgkmcnt(6)
    v_mfma_f32_16x16x32_bf16 v[28:31], v[92:95], v[166:169], v[28:31]
    ds_read_b64_tr_b16 v[76:77], v130 offset:12288
    v_mfma_f32_16x16x32_bf16 v[44:47], v[92:95], v[202:205], v[44:47]
    ds_read_b64_tr_b16 v[78:79], v131 offset:12288
    v_mfma_f32_16x16x32_bf16 v[60:63], v[92:95], v[238:241], v[60:63]
    s_waitcnt lgkmcnt(6)
    v_mfma_f32_16x16x32_bf16 v[20:23], v[64:67], v[170:173], v[20:23]
    ds_read_b64_tr_b16 v[80:81], v130 offset:14336
    v_mfma_f32_16x16x32_bf16 v[36:39], v[64:67], v[206:209], v[36:39]
    ds_read_b64_tr_b16 v[82:83], v131 offset:14336
    v_mfma_f32_16x16x32_bf16 v[52:55], v[64:67], v[242:245], v[52:55]
    s_waitcnt lgkmcnt(6)
    v_mfma_f32_16x16x32_bf16 v[20:23], v[68:71], v[174:177], v[20:23]
    ds_read_b64_tr_b16 v[84:85], v130 offset:16384
    v_mfma_f32_16x16x32_bf16 v[36:39], v[68:71], v[210:213], v[36:39]
    ds_read_b64_tr_b16 v[86:87], v131 offset:16384
    v_mfma_f32_16x16x32_bf16 v[52:55], v[68:71], v[246:249], v[52:55]
    s_waitcnt lgkmcnt(6)
    v_mfma_f32_16x16x32_bf16 v[20:23], v[72:75], v[178:181], v[20:23]
    ds_read_b64_tr_b16 v[88:89], v132 offset:12288
    v_mfma_f32_16x16x32_bf16 v[36:39], v[72:75], v[214:217], v[36:39]
    ds_read_b64_tr_b16 v[90:91], v133 offset:12288
    v_mfma_f32_16x16x32_bf16 v[52:55], v[72:75], v[250:253], v[52:55]
    s_waitcnt lgkmcnt(6)
    v_mfma_f32_16x16x32_bf16 v[24:27], v[76:79], v[170:173], v[24:27]
    ds_read_b64_tr_b16 v[92:93], v132 offset:14336
    v_mfma_f32_16x16x32_bf16 v[40:43], v[76:79], v[206:209], v[40:43]
    ds_read_b64_tr_b16 v[94:95], v133 offset:14336
    v_mfma_f32_16x16x32_bf16 v[56:59], v[76:79], v[242:245], v[56:59]
    s_waitcnt lgkmcnt(6)
    v_mfma_f32_16x16x32_bf16 v[24:27], v[80:83], v[174:177], v[24:27]
    ds_read_b64_tr_b16 v[64:65], v132 offset:16384
    v_mfma_f32_16x16x32_bf16 v[40:43], v[80:83], v[210:213], v[40:43]
    ds_read_b64_tr_b16 v[66:67], v133 offset:16384
    v_mfma_f32_16x16x32_bf16 v[56:59], v[80:83], v[246:249], v[56:59]
    ds_write_b128 v134, v[20:23] offset:0
    s_waitcnt lgkmcnt(7)
    v_mfma_f32_16x16x32_bf16 v[24:27], v[84:87], v[178:181], v[24:27]
    ds_read_b64_tr_b16 v[68:69], v126 offset:12288
    ds_write_b128 v134, v[36:39] offset:1024
    v_mfma_f32_16x16x32_bf16 v[40:43], v[84:87], v[214:217], v[40:43]
    ds_read_b64_tr_b16 v[70:71], v127 offset:12288
    ds_write_b128 v134, v[52:55] offset:2048
    v_mfma_f32_16x16x32_bf16 v[56:59], v[84:87], v[250:253], v[56:59]
    s_waitcnt lgkmcnt(9)
    v_mfma_f32_16x16x32_bf16 v[28:31], v[88:91], v[170:173], v[28:31]
    ds_read_b64_tr_b16 v[72:73], v126 offset:14336
    v_mfma_f32_16x16x32_bf16 v[44:47], v[88:91], v[206:209], v[44:47]
    ds_read_b64_tr_b16 v[74:75], v127 offset:14336
    v_mfma_f32_16x16x32_bf16 v[60:63], v[88:91], v[242:245], v[60:63]
    s_waitcnt lgkmcnt(9)
    v_mfma_f32_16x16x32_bf16 v[28:31], v[92:95], v[174:177], v[28:31]
    ds_read_b64_tr_b16 v[76:77], v126 offset:16384
    v_mfma_f32_16x16x32_bf16 v[44:47], v[92:95], v[210:213], v[44:47]
    ds_read_b64_tr_b16 v[78:79], v127 offset:16384
    v_mfma_f32_16x16x32_bf16 v[60:63], v[92:95], v[246:249], v[60:63]
    ds_write_b128 v135, v[24:27] offset:0
    s_waitcnt lgkmcnt(10)
    v_mfma_f32_16x16x32_bf16 v[28:31], v[64:67], v[178:181], v[28:31]
    ds_write_b128 v135, v[40:43] offset:1024
    v_mfma_f32_16x16x32_bf16 v[44:47], v[64:67], v[214:217], v[44:47]
    ds_write_b128 v135, v[56:59] offset:2048
    v_mfma_f32_16x16x32_bf16 v[60:63], v[64:67], v[250:253], v[60:63]
    s_waitcnt lgkmcnt(8)
    v_mfma_f32_16x16x32_bf16 v[16:19], v[68:71], v[170:173], v[16:19]
    v_mfma_f32_16x16x32_bf16 v[32:35], v[68:71], v[206:209], v[32:35]
    v_mfma_f32_16x16x32_bf16 v[48:51], v[68:71], v[242:245], v[48:51]
    s_waitcnt lgkmcnt(5)
    v_mfma_f32_16x16x32_bf16 v[16:19], v[72:75], v[174:177], v[16:19]
    v_mfma_f32_16x16x32_bf16 v[32:35], v[72:75], v[210:213], v[32:35]
    v_mfma_f32_16x16x32_bf16 v[48:51], v[72:75], v[246:249], v[48:51]
    ds_write_b128 v136, v[28:31] offset:0
    s_waitcnt lgkmcnt(4)
    v_mfma_f32_16x16x32_bf16 v[16:19], v[76:79], v[178:181], v[16:19]
    ds_write_b128 v136, v[44:47] offset:1024
    v_mfma_f32_16x16x32_bf16 v[32:35], v[76:79], v[214:217], v[32:35]
    ds_write_b128 v136, v[60:63] offset:2048
    v_mfma_f32_16x16x32_bf16 v[48:51], v[76:79], v[250:253], v[48:51]
    s_cmp_lt_u32 s5, 6
    s_cbranch_scc0 LB2_y1
    s_add_u32 m0, s19, 0
    s_add_u32 s74, s18, 0
    buffer_load_dwordx4 v139, s[40:43], s74 offen sc0 sc1 lds
    s_add_u32 m0, s19, 1024
    s_add_u32 s74, s18, 65536
    buffer_load_dwordx4 v139, s[40:43], s74 offen sc0 sc1 lds
LB2_y1:
    s_waitcnt lgkmcnt(0)
    s_barrier
    ds_read_b128 v[64:67], v137 offset:0
    ds_read_b128 v[68:71], v137 offset:3072
    ds_read_b128 v[72:75], v137 offset:6144
    ds_read_b128 v[76:79], v137 offset:1024
    ds_read_b128 v[80:83], v137 offset:4096
    ds_read_b128 v[84:87], v137 offset:7168
    ds_read_b128 v[88:91], v137 offset:2048
    ds_read_b128 v[92:95], v137 offset:5120
    ds_read_b128 v[96:99], v137 offset:8192
    s_waitcnt lgkmcnt(6)
    v_pk_add_f32 v[16:17], v[16:17], v[64:65]
    v_pk_add_f32 v[68:69], v[68:69], v[72:73]
    v_pk_add_f32 v[16:17], v[16:17], v[68:69]
    v_pk_add_f32 v[18:19], v[18:19], v[66:67]
    v_pk_add_f32 v[70:71], v[70:71], v[74:75]
    v_pk_add_f32 v[18:19], v[18:19], v[70:71]
    buffer_store_dword v16, v105, s[44:47], 0 offen offset:0 nt
    buffer_store_dword v17, v105, s[44:47], s70 offen offset:0 nt
    buffer_store_dword v18, v105, s[44:47], s71 offen offset:0 nt
    buffer_store_dword v19, v105, s[44:47], s72 offen offset:0 nt
    s_waitcnt lgkmcnt(3)
    v_pk_add_f32 v[32:33], v[32:33], v[76:77]
    v_pk_add_f32 v[80:81], v[80:81], v[84:85]
    v_pk_add_f32 v[32:33], v[32:33], v[80:81]
    v_pk_add_f32 v[34:35], v[34:35], v[78:79]
    v_pk_add_f32 v[82:83], v[82:83], v[86:87]
    v_pk_add_f32 v[34:35], v[34:35], v[82:83]
    buffer_store_dword v32, v105, s[44:47], 0 offen offset:64 nt
    buffer_store_dword v33, v105, s[44:47], s70 offen offset:64 nt
    buffer_store_dword v34, v105, s[44:47], s71 offen offset:64 nt
    buffer_store_dword v35, v105, s[44:47], s72 offen offset:64 nt
    s_waitcnt lgkmcnt(0)
    v_pk_add_f32 v[48:49], v[48:49], v[88:89]
    v_pk_add_f32 v[92:93], v[92:93], v[96:97]
    v_pk_add_f32 v[48:49], v[48:49], v[92:93]
    v_pk_add_f32 v[50:51], v[50:51], v[90:91]
    v_pk_add_f32 v[94:95], v[94:95], v[98:99]
    v_pk_add_f32 v[50:51], v[50:51], v[94:95]
    buffer_store_dword v48, v105, s[44:47], 0 offen offset:128 nt
    buffer_store_dword v49, v105, s[44:47], s70 offen offset:128 nt
    buffer_store_dword v50, v105, s[44:47], s71 offen offset:128 nt
    buffer_store_dword v51, v105, s[44:47], s72 offen offset:128 nt
    s_cmp_lt_u32 s5, 6
    s_cbranch_scc0 LB2_y3
    s_mov_b32 s78, 0
    s_mov_b32 s70, 0xffff
    s_waitcnt vmcnt(12)
LB2_ychk:
    ds_read_b64 v[64:65], v140 offset:0
    ds_read_b64 v[66:67], v140 offset:64
    ds_read_b64 v[68:69], v140 offset:128
    ds_read_b64 v[70:71], v140 offset:192
    s_add_u32 s78, s78, 1
    s_waitcnt lgkmcnt(0)
    v_lshlrev_b32 v72, 16, v64
    v_and_b32 v76, 0xffff0000, v64
    v_lshlrev_b32 v80, 16, v65
    v_and_b32 v84, 0xffff0000, v65
    v_lshlrev_b32 v73, 16, v66
    v_and_b32 v77, 0xffff0000, v66
    v_lshlrev_b32 v81, 16, v67
    v_and_b32 v85, 0xffff0000, v67
    v_lshlrev_b32 v74, 16, v68
    v_and_b32 v78, 0xffff0000, v68
    v_lshlrev_b32 v82, 16, v69
    v_and_b32 v86, 0xffff0000, v69
    v_lshlrev_b32 v75, 16, v70
    v_and_b32 v79, 0xffff0000, v70
    v_lshlrev_b32 v83, 16, v71
    v_and_b32 v87, 0xffff0000, v71
    v_max3_u32 v40, v72, v73, v74
    v_max3_u32 v40, v40, v75, v76
    v_max3_u32 v40, v40, v77, v78
    v_max3_u32 v40, v40, v79, v80
    v_max3_u32 v40, v40, v81, v82
    v_max3_u32 v40, v40, v83, v84
    v_max3_u32 v40, v40, v85, v86
    v_max_u32 v40, v40, v87
    v_cmp_le_u32 vcc, 0xffff0000, v40
    s_cmp_ge_u32 s78, 40000
    s_cbranch_scc1 LB2_ygo
    s_cbranch_vccz LB2_ygo
    s_sleep 3
    s_add_u32 m0, s19, 0
    s_add_u32 s74, s18, 0
    buffer_load_dwordx4 v139, s[40:43], s74 offen sc0 sc1 lds
    s_add_u32 m0, s19, 1024
    s_add_u32 s74, s18, 65536
    buffer_load_dwordx4 v139, s[40:43], s74 offen sc0 sc1 lds
    s_waitcnt vmcnt(0)
    s_branch LB2_ychk
LB2_ygo:
    s_mov_b32 s70, 0
    buffer_store_dwordx4 v[72:75], v141, s[44:47], s70 offen nt
    s_add_u32 s70, s70, 4608
    buffer_store_dwordx4 v[76:79], v141, s[44:47], s70 offen nt
    s_add_u32 s70, s70, 4608
    buffer_store_dwordx4 v[80:83], v141, s[44:47], s70 offen nt
    s_add_u32 s70, s70, 4608
    buffer_store_dwordx4 v[84:87], v141, s[44:47], s70 offen nt
LB2_y3:
    s_cmp_eq_u32 s2, 167
    s_cbranch_scc0 LB2_noep
    s_cmp_eq_u32 s5, 7
    s_cbranch_scc0 LB2_noep
    v_mov_b32 v1, s6
    v_mov_b32 v2, 0
    s_mov_b64 exec, 1
    buffer_store_dword v1, v2, s[40:43], 0 offen sc0 sc1
    s_mov_b64 exec, -1
LB2_noep:
    s_endpgm
LB_setup:
    s_cmp_ge_u32 s76, 2
    s_cselect_b32 s52, s28, s26
    s_cselect_b32 s53, s29, s27
    s_and_b32 s53, s53, 0xffff
    s_mov_b32 s54, 663552
    s_mov_b32 s55, 0x20000
    s_mul_i32 s10, s77, 48
    s_add_u32 s10, s10, s59
    s_mul_i32 s12, s10, 1152
    s_and_b32 s11, s76, 1
    s_lshl_b32 s13, s11, 6
    s_add_u32 s13, s13, s12
    s_add_u32 s13, s13, 512
    s_mul_i32 s8, s11, 640
    s_add_u32 s12, s12, s8
    s_lshl_b32 s14, s5, 2
    s_lshr_b32 s14, 0x3217654, s14
    s_and_b32 s14, s14, 7
    s_mul_i32 s14, s14, 18432
    v_lshrrev_b32 v250, 4, v0
    v_and_b32 v251, 15, v0
    v_lshrrev_b32 v253, 1, v250
    v_xor_b32 v252, v253, v250
    v_and_b32 v252, 1, v252
    v_lshl_or_b32 v252, v252, 1, v253
    v_and_b32 v253, 3, v0
    v_xor_b32 v252, v252, v253
    v_lshrrev_b32 v253, 2, v0
    v_mul_u32_u24 v253, 1152, v253
    v_lshl_add_u32 v98, v252, 4, v253
    v_and_b32 v252, 7, v0
    v_xor_b32 v252, v252, v250
    v_lshrrev_b32 v253, 3, v0
    v_mul_u32_u24 v253, 1152, v253
    v_lshl_add_u32 v96, v252, 4, v253
    v_xor_b32 v97, 64, v96
    v_add_u32 v97, 9216, v97
    v_bfe_u32 v125, v0, 2, 2
    v_lshrrev_b32 v253, 1, v125
    v_xor_b32 v252, v253, v125
    v_and_b32 v252, 1, v252
    v_lshl_or_b32 v252, v252, 1, v253
    v_xor_b32 v252, v252, v250
    v_lshlrev_b32 v252, 4, v252
    v_lshl_add_u32 v252, v251, 6, v252
    v_add_u32 v101, s14, v252
    v_bfe_u32 v252, v0, 1, 3
    v_xor_b32 v252, v252, v250
    v_lshlrev_b32 v252, 4, v252
    v_lshl_add_u32 v252, v251, 7, v252
    v_add_u32 v99, s14, v252
    v_xor_b32 v100, 64, v99
    v_lshrrev_b32 v252, 1, v250
    v_lshlrev_b32 v252, 3, v252
    v_and_b32 v253, 1, v250
    v_lshl_add_u32 v252, v253, 1, v252
    s_lshl_b32 s8, s58, 6
    s_lshl_b32 s9, s76, 4
    s_add_u32 s8, s8, s9
    v_add_u32 v252, s8, v252
    v_add_u32 v253, s10, v251
    v_mul_u32_u24 v102, 1152, v252
    v_lshl_add_u32 v102, v253, 1, v102
    v_and_b32 v102, -4, v102
    v_add_u32 v103, 4608, v102
    v_lshlrev_b32 v104, 1, v253
    v_and_b32 v104, -4, v104
    v_mul_u32_u24 v105, 4608, v252
    v_lshl_add_u32 v105, v253, 2, v105
    v_add_u32 v105, 2304, v105
    v_and_b32 v106, 1, v0
    v_lshlrev_b32 v106, 4, v106
    v_sub_u32 v106, 16, v106
    v_and_b32 v252, 1, v250
    v_lshl_add_u32 v125, v252, 3, v125
    v_bfe_u32 v252, v0, 1, 1
    v_lshlrev_b32 v253, 2, v252
    v_xor_b32 v125, v125, v253
    v_lshlrev_b32 v125, 4, v125
    v_lshl_add_u32 v125, v252, 8, v125
    v_and_b32 v252, 1, v0
    v_lshl_add_u32 v125, v252, 3, v125
    v_lshrrev_b32 v252, 1, v250
    v_lshl_add_u32 v125, v252, 10, v125
    v_lshlrev_b32 v107, 4, v0
    s_lshl_b32 s10, s79, 1
    s_sub_u32 s10, s76, s10
    s_add_u32 s10, s10, 8
    s_add_u32 s8, s76, 0
    s_and_b32 s9, s8, 2
    s_lshl_b32 s9, s9, 1
    s_add_u32 s9, s9, s10
    s_and_b32 s9, s9, 7
    s_lshl_b32 s9, s9, 2
    s_lshr_b32 s9, 0x3217654, s9
    s_and_b32 s9, s9, 7
    s_mul_i32 s9, s9, 18432
    s_bitcmp1_b32 s8, 0
    s_cselect_b32 s37, 512, 0
    s_add_u32 s9, s9, s37
    v_add_u32 v126, s9, v125
    v_xor_b32 v127, 64, v126
    s_and_b32 s8, s8, 3
    s_sub_u32 s8, s8, s76
    s_lshl_b32 s9, s77, 2
    s_add_u32 s8, s8, s9
    s_add_u32 s8, s8, s10
    s_and_b32 s8, s8, 7
    s_lshl_b32 s8, s8, 2
    s_lshr_b32 s8, 0x3217654, s8
    s_and_b32 s8, s8, 7
    s_mul_i32 s8, s8, 18432
    v_add_u32 v137, s8, v107
    s_add_u32 s8, s76, 1
    s_and_b32 s9, s8, 2
    s_lshl_b32 s9, s9, 1
    s_add_u32 s9, s9, s10
    s_and_b32 s9, s9, 7
    s_lshl_b32 s9, s9, 2
    s_lshr_b32 s9, 0x3217654, s9
    s_and_b32 s9, s9, 7
    s_mul_i32 s9, s9, 18432
    s_bitcmp1_b32 s8, 0
    s_cselect_b32 s37, 512, 0
    s_add_u32 s9, s9, s37
    v_add_u32 v128, s9, v125
    v_xor_b32 v129, 64, v128
    s_and_b32 s8, s8, 3
    s_sub_u32 s8, s8, s76
    s_lshl_b32 s9, s77, 2
    s_add_u32 s8, s8, s9
    s_add_u32 s8, s8, s10
    s_and_b32 s8, s8, 7
    s_lshl_b32 s8, s8, 2
    s_lshr_b32 s8, 0x3217654, s8
    s_and_b32 s8, s8, 7
    s_mul_i32 s8, s8, 18432
    v_add_u32 v134, s8, v107
    s_add_u32 s8, s76, 2
    s_and_b32 s9, s8, 2
    s_lshl_b32 s9, s9, 1
    s_add_u32 s9, s9, s10
    s_and_b32 s9, s9, 7
    s_lshl_b32 s9, s9, 2
    s_lshr_b32 s9, 0x3217654, s9
    s_and_b32 s9, s9, 7
    s_mul_i32 s9, s9, 18432
    s_bitcmp1_b32 s8, 0
    s_cselect_b32 s37, 512, 0
    s_add_u32 s9, s9, s37
    v_add_u32 v130, s9, v125
    v_xor_b32 v131, 64, v130
    s_and_b32 s8, s8, 3
    s_sub_u32 s8, s8, s76
    s_lshl_b32 s9, s77, 2
    s_add_u32 s8, s8, s9
    s_add_u32 s8, s8, s10
    s_and_b32 s8, s8, 7
    s_lshl_b32 s8, s8, 2
    s_lshr_b32 s8, 0x3217654, s8
    s_and_b32 s8, s8, 7
    s_mul_i32 s8, s8, 18432
    s_add_u32 s8, s8, 3072
    v_add_u32 v135, s8, v107
    s_add_u32 s8, s76, 3
    s_and_b32 s9, s8, 2
    s_lshl_b32 s9, s9, 1
    s_add_u32 s9, s9, s10
    s_and_b32 s9, s9, 7
    s_lshl_b32 s9, s9, 2
    s_lshr_b32 s9, 0x3217654, s9
    s_and_b32 s9, s9, 7
    s_mul_i32 s9, s9, 18432
    s_bitcmp1_b32 s8, 0
    s_cselect_b32 s37, 512, 0
    s_add_u32 s9, s9, s37
    v_add_u32 v132, s9, v125
    v_xor_b32 v133, 64, v132
    s_and_b32 s8, s8, 3
    s_sub_u32 s8, s8, s76
    s_lshl_b32 s9, s77, 2
    s_add_u32 s8, s8, s9
    s_add_u32 s8, s8, s10
    s_and_b32 s8, s8, 7
    s_lshl_b32 s8, s8, 2
    s_lshr_b32 s8, 0x3217654, s8
    s_and_b32 s8, s8, 7
    s_mul_i32 s8, s8, 18432
    s_add_u32 s8, s8, 6144
    v_add_u32 v136, s8, v107
    s_lshl_b32 s15, s58, 1
    s_add_u32 s15, s15, s77
    s_mul_i32 s15, s15, 73728
    s_mul_i32 s8, s76, 18432
    s_add_u32 s15, s15, s8
    s_add_u32 s15, s15, 1048576
    s_lshl_b32 s8, s11, 14
    s_sub_u32 s36, s15, s8
    s_lshl_b32 s8, s11, 11
    s_add_u32 s15, s15, s8
    s_lshl_b32 s37, s58, 7
    s_lshl_b32 s37, s37, 5
    s_add_u32 s37, s37, 524288
    s_mul_i32 s8, s3, 24
    s_add_u32 s8, s8, s4
    s_mul_i32 s9, s8, 0x5556
    s_lshr_b32 s9, s9, 16
    s_mul_i32 s10, s9, 3
    s_sub_u32 s10, s8, s10
    s_mul_i32 s10, s10, 192
    s_lshl_b32 s8, s5, 5
    s_add_u32 s10, s10, s8
    s_lshl_b32 s18, s10, 12
    s_lshl_b32 s8, s9, 6
    s_add_u32 s18, s18, s8
    s_add_u32 s18, s18, 6291456
    v_lshlrev_b32 v138, 7, v0
    v_add_u32 v138, 655360, v138
    v_and_b32 v252, 3, v0
    v_xor_b32 v252, v252, v250
    v_lshrrev_b32 v253, 2, v0
    v_lshlrev_b32 v253, 12, v253
    v_lshl_add_u32 v139, v252, 4, v253
    s_lshl_b32 s19, s5, 11
    s_add_u32 s19, s19, 147456
    v_lshrrev_b32 v253, 3, v0
    v_and_b32 v125, 7, v0
    v_lshrrev_b32 v252, 4, v0
    v_xor_b32 v252, v252, v0
    v_and_b32 v252, 3, v252
    v_lshlrev_b32 v252, 4, v252
    v_lshl_add_u32 v252, v125, 8, v252
    v_and_b32 v140, 8, v0
    v_add3_u32 v140, v140, v252, s19
    s_mul_i32 s9, s9, 147456
    s_lshl_b32 s10, s10, 2
    s_add_u32 s9, s9, s10
    v_mul_u32_u24 v253, 18432, v253
    v_lshl_add_u32 v253, v125, 4, v253
    v_add_u32 v141, s9, v253
    v_min_u32 v108, 23, v0
    v_lshlrev_b32 v108, 7, v108
    s_setpc_b64 s[30:31]
LB_c1:
    s_add_u32 s8, s12, 0
    s_add_u32 m0, s14, 0
    s_nop 0
    buffer_load_dwordx4 v96, s[52:55], s8 offen lds
    s_add_u32 m0, s14, 1024
    s_nop 0
    buffer_load_dwordx4 v97, s[52:55], s8 offen lds
    s_add_u32 s8, s12, 128
    s_add_u32 m0, s14, 2048
    s_nop 0
    buffer_load_dwordx4 v96, s[52:55], s8 offen lds
    s_add_u32 m0, s14, 3072
    s_nop 0
    buffer_load_dwordx4 v97, s[52:55], s8 offen lds
    s_add_u32 s8, s12, 256
    s_add_u32 m0, s14, 4096
    s_nop 0
    buffer_load_dwordx4 v96, s[52:55], s8 offen lds
    s_add_u32 m0, s14, 5120
    s_nop 0
    buffer_load_dwordx4 v97, s[52:55], s8 offen lds
    s_add_u32 s8, s12, 384
    s_add_u32 m0, s14, 6144
    s_nop 0
    buffer_load_dwordx4 v96, s[52:55], s8 offen lds
    s_add_u32 m0, s14, 7168
    s_nop 0
    buffer_load_dwordx4 v97, s[52:55], s8 offen lds
    s_add_u32 m0, s14, 8192
    s_add_u32 s8, s13, 0
    buffer_load_dwordx4 v98, s[52:55], s8 offen lds
LB_c1b:
    s_add_u32 s8, s12, 18432
    s_add_u32 m0, s14, 9216
    s_nop 0
    buffer_load_dwordx4 v96, s[52:55], s8 offen lds
    s_add_u32 m0, s14, 10240
    s_nop 0
    buffer_load_dwordx4 v97, s[52:55], s8 offen lds
    s_add_u32 s8, s12, 18560
    s_add_u32 m0, s14, 11264
    s_nop 0
    buffer_load_dwordx4 v96, s[52:55], s8 offen lds
    s_add_u32 m0, s14, 12288
    s_nop 0
    buffer_load_dwordx4 v97, s[52:55], s8 offen lds
    s_add_u32 s8, s12, 18688
    s_add_u32 m0, s14, 13312
    s_nop 0
    buffer_load_dwordx4 v96, s[52:55], s8 offen lds
    s_add_u32 m0, s14, 14336
    s_nop 0
    buffer_load_dwordx4 v97, s[52:55], s8 offen lds
    s_add_u32 s8, s12, 18816
    s_add_u32 m0, s14, 15360
    s_nop 0
    buffer_load_dwordx4 v96, s[52:55], s8 offen lds
    s_add_u32 m0, s14, 16384
    s_nop 0
    buffer_load_dwordx4 v97, s[52:55], s8 offen lds
    s_add_u32 m0, s14, 17408
    s_add_u32 s8, s13, 18432
    buffer_load_dwordx4 v98, s[52:55], s8 offen lds
    s_setpc_b64 s[30:31]
LB_c1a:
    s_add_u32 s8, s12, 0
    s_add_u32 m0, s14, 0
    s_nop 0
    buffer_load_dwordx4 v96, s[52:55], s8 offen lds
    s_add_u32 m0, s14, 1024
    s_nop 0
    buffer_load_dwordx4 v97, s[52:55], s8 offen lds
    s_add_u32 s8, s12, 128
    s_add_u32 m0, s14, 2048
    s_nop 0
    buffer_load_dwordx4 v96, s[52:55], s8 offen lds
    s_add_u32 m0, s14, 3072
    s_nop 0
    buffer_load_dwordx4 v97, s[52:55], s8 offen lds
    s_add_u32 s8, s12, 256
    s_add_u32 m0, s14, 4096
    s_nop 0
    buffer_load_dwordx4 v96, s[52:55], s8 offen lds
    s_add_u32 m0, s14, 5120
    s_nop 0
    buffer_load_dwordx4 v97, s[52:55], s8 offen lds
    s_add_u32 s8, s12, 384
    s_add_u32 m0, s14, 6144
    s_nop 0
    buffer_load_dwordx4 v96, s[52:55], s8 offen lds
    s_add_u32 m0, s14, 7168
    s_nop 0
    buffer_load_dwordx4 v97, s[52:55], s8 offen lds
    s_add_u32 m0, s14, 8192
    s_add_u32 s8, s13, 0
    buffer_load_dwordx4 v98, s[52:55], s8 offen lds
    s_setpc_b64 s[30:31]
LB_c2:
    s_waitcnt vmcnt(9)
    ds_read_b128 v[146:149], v99 offset:0
    ds_read_b128 v[150:153], v100 offset:0
    ds_read_b128 v[154:157], v99 offset:2048
    ds_read_b128 v[158:161], v100 offset:2048
    ds_read_b128 v[162:165], v99 offset:4096
    ds_read_b128 v[166:169], v100 offset:4096
    ds_read_b128 v[170:173], v99 offset:6144
    ds_read_b128 v[174:177], v100 offset:6144
    ds_read_b128 v[178:181], v101 offset:8192
    s_waitcnt lgkmcnt(0)
    s_add_u32 s8, s12, 36864
    s_add_u32 m0, s14, 0
    s_nop 0
    buffer_load_dwordx4 v96, s[52:55], s8 offen lds
    s_add_u32 m0, s14, 1024
    s_nop 0
    buffer_load_dwordx4 v97, s[52:55], s8 offen lds
    s_add_u32 s8, s12, 36992
    s_add_u32 m0, s14, 2048
    s_nop 0
    buffer_load_dwordx4 v96, s[52:55], s8 offen lds
    s_add_u32 m0, s14, 3072
    s_nop 0
    buffer_load_dwordx4 v97, s[52:55], s8 offen lds
    s_add_u32 s8, s12, 37120
    s_add_u32 m0, s14, 4096
    s_nop 0
    buffer_load_dwordx4 v96, s[52:55], s8 offen lds
    s_add_u32 m0, s14, 5120
    s_nop 0
    buffer_load_dwordx4 v97, s[52:55], s8 offen lds
    s_add_u32 s8, s12, 37248
    s_add_u32 m0, s14, 6144
    s_nop 0
    buffer_load_dwordx4 v96, s[52:55], s8 offen lds
    s_add_u32 m0, s14, 7168
    s_nop 0
    buffer_load_dwordx4 v97, s[52:55], s8 offen lds
    s_add_u32 m0, s14, 8192
    s_add_u32 s8, s13, 36864
    buffer_load_dwordx4 v98, s[52:55], s8 offen lds
    global_load_dword v110, v102, s[16:17] offset:0
    global_load_dword v111, v103, s[16:17] offset:0
    global_load_dword v112, v102, s[16:17] offset:1152
    global_load_dword v113, v103, s[16:17] offset:1152
    global_load_dword v122, v104, s[32:33] offset:0
    global_load_dword v114, v102, s[16:17] offset:32
    global_load_dword v115, v103, s[16:17] offset:32
    global_load_dword v116, v102, s[16:17] offset:1184
    global_load_dword v117, v103, s[16:17] offset:1184
    global_load_dword v123, v104, s[32:33] offset:32
    global_load_dword v118, v102, s[16:17] offset:64
    global_load_dword v119, v103, s[16:17] offset:64
    global_load_dword v120, v102, s[16:17] offset:1216
    global_load_dword v121, v103, s[16:17] offset:1216
    global_load_dword v124, v104, s[32:33] offset:64
    s_waitcnt vmcnt(24)
    ds_read_b128 v[182:185], v99 offset:9216
    ds_read_b128 v[186:189], v100 offset:9216
    ds_read_b128 v[190:193], v99 offset:11264
    ds_read_b128 v[194:197], v100 offset:11264
    ds_read_b128 v[198:201], v99 offset:13312
    ds_read_b128 v[202:205], v100 offset:13312
    ds_read_b128 v[206:209], v99 offset:15360
    ds_read_b128 v[210:213], v100 offset:15360
    ds_read_b128 v[214:217], v101 offset:17408
    s_setpc_b64 s[30:31]
LB_c3:
    s_waitcnt vmcnt(15)
    ds_read_b128 v[218:221], v99 offset:0
    ds_read_b128 v[222:225], v100 offset:0
    ds_read_b128 v[226:229], v99 offset:2048
    ds_read_b128 v[230:233], v100 offset:2048
    ds_read_b128 v[234:237], v99 offset:4096
    ds_read_b128 v[238:241], v100 offset:4096
    ds_read_b128 v[242:245], v99 offset:6144
    ds_read_b128 v[246:249], v100 offset:6144
    ds_read_b128 v[250:253], v101 offset:8192
    s_setpc_b64 s[30:31]
LA_entry:
    s_lshl_b32 s56, s3, 3
    s_add_u32 s56, s56, s4
    s_sub_u32 s56, s56, 24
    s_lshl_b32 s57, s56, 3
    s_mov_b32 s71, s5
    s_add_u32 s72, s57, s71
    s_lshl_b32 s73, s72, 8
    v_lshl_add_u32 v2, v0, 2, s73
    s_lshl_b32 s73, s72, 1
    v_mov_b32 v3, s73
    s_add_u32 s72, s56, 512
    s_lshl_b32 s73, s72, 8
    v_lshl_add_u32 v4, v0, 2, s73
    s_lshl_b32 s73, s72, 1
    v_mov_b32 v5, s73
    v_mov_b32 v12, 163440
    v_mov_b32 v8, 0
    v_mov_b32 v9, 0
    v_mov_b32 v10, 0
    v_mov_b32 v11, 0
    ds_write_b128 v12, v[8:11]
    ds_write_b128 v12, v[8:11] offset:16
    s_waitcnt lgkmcnt(0)
    global_load_dword v202, v2, s[18:19]
    global_load_dword v203, v2, s[20:21]
    global_load_dword v204, v2, s[22:23]
    global_load_dword v205, v2, s[24:25]
    global_load_ushort v206, v3, s[26:27]
    global_load_ushort v207, v3, s[28:29]
    global_load_dword v208, v4, s[18:19]
    global_load_dword v209, v4, s[20:21]
    global_load_dword v210, v4, s[22:23]
    global_load_dword v211, v4, s[24:25]
    global_load_ushort v212, v5, s[26:27]
    global_load_ushort v213, v5, s[28:29]
    s_barrier
    s_load_dword s6, s[38:39], 0
    s_and_b32 s72, s5, 1
    s_lshl_b32 s72, s72, 3
    s_add_u32 s72, s72, 96
    s_load_dwordx2 s[12:13], s[0:1], s72
    s_lshl_b32 s72, s56, 1
    s_bfe_u32 s73, s5, 0x10001
    s_add_u32 s72, s72, s73
    s_mul_i32 s72, s72, 41
    v_min_u32 v230, 40, v0
    v_add_u32 v230, s72, v230
    v_min_u32 v230, 5183, v230
    v_lshlrev_b32 v230, 7, v230
    s_mov_b32 s44, s16
    s_and_b32 s45, s17, 0xffff
    s_mov_b32 s46, 2359296
    s_mov_b32 s47, 0x20000
    s_mov_b32 s40, s38
    s_and_b32 s41, s39, 0xffff
    s_mov_b32 s42, 14680064
    s_mov_b32 s43, 0x20000
    s_and_b32 s75, s5, 3
    s_lshl_b32 s75, s75, 6
    v_add_u32 v1, s75, v0
    s_mul_i32 s63, s5, 5248
    s_add_u32 s63, s63, 110960
    v_lshrrev_b32 v14, 3, v0
    v_and_b32 v15, 7, v0
    v_mul_u32_u24 v14, 1152, v14
    v_lshl_add_u32 v14, v15, 4, v14
    s_cmp_eq_u32 s5, 3
    s_cbranch_scc0 LA_no9
    s_mul_i32 s74, s56, 36864
    s_mov_b32 m0, 152944
    s_add_u32 s73, s74, 1024
    buffer_load_dwordx4 v14, s[44:47], s73 offen lds
    s_mov_b32 m0, 153968
    s_add_u32 s73, s74, 10240
    buffer_load_dwordx4 v14, s[44:47], s73 offen lds
    s_mov_b32 m0, 154992
    s_add_u32 s73, s74, 19456
    buffer_load_dwordx4 v14, s[44:47], s73 offen lds
    s_mov_b32 m0, 156016
    s_add_u32 s73, s74, 28672
    buffer_load_dwordx4 v14, s[44:47], s73 offen lds
LA_no9:
    v_mov_b32 v231, v14
    s_cmp_ge_u32 s5, 4
    s_cbranch_scc0 LA_nowarm
    s_and_b32 s73, s4, 7
    s_lshl_b32 s73, s73, 2
    s_and_b32 s72, s5, 3
    s_add_u32 s73, s73, s72
    s_mul_i32 s73, s73, 73728
    s_lshl_b32 s74, s3, 7
    s_add_u32 s74, s74, s73
    s_add_u32 s73, s74, 0
    buffer_load_dwordx4 v[232:235], v231, s[44:47], s73 offen
    s_add_u32 s73, s74, 9216
    buffer_load_dwordx4 v[232:235], v231, s[44:47], s73 offen
    s_add_u32 s73, s74, 18432
    buffer_load_dwordx4 v[232:235], v231, s[44:47], s73 offen
    s_add_u32 s73, s74, 27648
    buffer_load_dwordx4 v[232:235], v231, s[44:47], s73 offen
    s_add_u32 s73, s74, 36864
    buffer_load_dwordx4 v[232:235], v231, s[44:47], s73 offen
    s_add_u32 s73, s74, 46080
    buffer_load_dwordx4 v[232:235], v231, s[44:47], s73 offen
    s_add_u32 s73, s74, 55296
    buffer_load_dwordx4 v[232:235], v231, s[44:47], s73 offen
    s_add_u32 s73, s74, 64512
    buffer_load_dwordx4 v[232:235], v231, s[44:47], s73 offen
LA_nowarm:
    s_lshl_b32 s72, s5, 6
    v_add_u32 v4, s72, v0
    v_mul_u32_u24 v5, 4608, v4
    s_lshl_b32 s59, s56, 4
    v_lshlrev_b32 v4, 3, v4
    v_add_u32 v4, 70128, v4
    s_mov_b32 s76, 0x05040100
    s_mov_b32 s77, 0x07060302
    s_mul_i32 s64, s71, 4592
    s_add_u32 s64, s64, 69632
    v_lshl_add_u32 v7, v0, 4, s64
    s_mov_b64 exec, 0x7fffffff
    ds_write_b128 v7, v[8:11]
    s_mov_b64 exec, -1
    v_lshl_add_u32 v7, v0, 4, s63
    ds_write_b128 v7, v[8:11] offset:0
    ds_write_b128 v7, v[8:11] offset:1024
    ds_write_b128 v7, v[8:11] offset:2048
    ds_write_b128 v7, v[8:11] offset:3072
    ds_write_b128 v7, v[8:11] offset:4096
    s_mov_b64 exec, 0xff
    ds_write_b128 v7, v[8:11] offset:5120
    s_mov_b64 exec, -1
    s_cmp_eq_u32 s5, 5
    s_cbranch_scc0 LA_zd2
    v_lshl_add_u32 v7, v0, 4, s63
    ds_write_b128 v7, v[8:11] offset:20992
    ds_write_b128 v7, v[8:11] offset:22016
    ds_write_b128 v7, v[8:11] offset:23040
    ds_write_b128 v7, v[8:11] offset:24064
    ds_write_b128 v7, v[8:11] offset:25088
    s_mov_b64 exec, 0xff
    ds_write_b128 v7, v[8:11] offset:26112
    s_mov_b64 exec, -1
LA_zd2:
    v_and_b32 v12, 15, v0
    v_lshrrev_b32 v13, 4, v0
    v_lshlrev_b32 v14, 3, v13
    s_mov_b32 s72, 0x3f80
    v_mov_b32 v15, 0xfe0
    v_lshlrev_b32 v15, v12, v15
    v_lshrrev_b32 v15, v14, v15
    v_bfe_u32 v7, v15, 0, 1
    v_bfe_u32 v236, v15, 1, 1
    v_lshl_or_b32 v236, v236, 16, v7
    v_mul_u32_u24 v236, s72, v236
    v_bfe_u32 v7, v15, 2, 1
    v_bfe_u32 v237, v15, 3, 1
    v_lshl_or_b32 v237, v237, 16, v7
    v_mul_u32_u24 v237, s72, v237
    v_bfe_u32 v7, v15, 4, 1
    v_bfe_u32 v238, v15, 5, 1
    v_lshl_or_b32 v238, v238, 16, v7
    v_mul_u32_u24 v238, s72, v238
    v_bfe_u32 v7, v15, 6, 1
    v_bfe_u32 v239, v15, 7, 1
    v_lshl_or_b32 v239, v239, 16, v7
    v_mul_u32_u24 v239, s72, v239
    v_mov_b32 v15, 0x1ff0
    v_lshlrev_b32 v15, v12, v15
    v_lshrrev_b32 v15, v14, v15
    v_bfe_u32 v7, v15, 0, 1
    v_bfe_u32 v240, v15, 1, 1
    v_lshl_or_b32 v240, v240, 16, v7
    v_mul_u32_u24 v240, s72, v240
    v_bfe_u32 v7, v15, 2, 1
    v_bfe_u32 v241, v15, 3, 1
    v_lshl_or_b32 v241, v241, 16, v7
    v_mul_u32_u24 v241, s72, v241
    v_bfe_u32 v7, v15, 4, 1
    v_bfe_u32 v242, v15, 5, 1
    v_lshl_or_b32 v242, v242, 16, v7
    v_mul_u32_u24 v242, s72, v242
    v_bfe_u32 v7, v15, 6, 1
    v_bfe_u32 v243, v15, 7, 1
    v_lshl_or_b32 v243, v243, 16, v7
    v_mul_u32_u24 v243, s72, v243
    v_mov_b32 v15, 0x10000
    v_lshlrev_b32 v15, v12, v15
    v_lshrrev_b32 v15, v14, v15
    v_bfe_u32 v7, v15, 0, 1
    v_bfe_u32 v244, v15, 1, 1
    v_lshl_or_b32 v244, v244, 16, v7
    v_bfe_u32 v7, v15, 2, 1
    v_bfe_u32 v245, v15, 3, 1
    v_lshl_or_b32 v245, v245, 16, v7
    v_bfe_u32 v7, v15, 4, 1
    v_bfe_u32 v246, v15, 5, 1
    v_lshl_or_b32 v246, v246, 16, v7
    v_bfe_u32 v7, v15, 6, 1
    v_bfe_u32 v247, v15, 7, 1
    v_lshl_or_b32 v247, v247, 16, v7
    s_mul_i32 s62, s5, 8704
    s_cmp_ge_u32 s5, 6
    s_cselect_b32 s73, 0, 0
    s_add_u32 s62, s62, s73
    v_mul_u32_u24 v6, 544, v12
    v_lshl_add_u32 v6, v13, 4, v6
    v_add_u32 v2, s62, v6
    v_lshl_add_u32 v10, v0, 3, s62
    s_mov_b32 s78, 0
    s_mov_b32 s79, 0xffff0000
    v_lshlrev_b32 v7, 5, v12
    v_lshl_add_u32 v8, v13, 3, v7
    v_lshl_add_u32 v9, v13, 4, v7
    v_and_b32 v14, 1, v12
    v_mul_u32_u24 v11, 2238, v14
    v_lshl_add_u32 v11, v12, 1, v11
    v_lshlrev_b32 v15, 4, v13
    v_sub_u32 v11, v15, v11
    v_mul_u32_u24 v7, 190, v14
    v_lshl_add_u32 v7, v12, 1, v7
    v_lshlrev_b32 v15, 3, v13
    v_sub_u32 v7, v15, v7
    s_waitcnt lgkmcnt(0)
    s_mul_i32 s6, s6, 0x9E3779B1
    s_add_u32 s6, s6, 0x7F4A7C15
    s_cmp_ge_u32 s5, 4
    s_cbranch_scc1 LA_wy
    s_cmp_eq_u32 s5, 3
    s_cbranch_scc1 LA_w3
    s_waitcnt vmcnt(0)
LA_w3:
    s_waitcnt vmcnt(4)
LA_wy:
    s_waitcnt vmcnt(8)
LA_kgen:
    s_mov_b32 m0, s62
    v_readfirstlane_b32 s70, v207
    v_lshlrev_b32 v15, 16, v206
    v_mul_f32 v15, 0x3fb8aa3b, v15
    v_exp_f32 v15, v15
    s_nop 0
    v_cvt_pk_bf16_f32 v15, v15, v15
    v_lshlrev_b32 v15, 16, v15
    s_cmp_ge_u32 s5, 4
    s_cbranch_scc1 LA_kgy
    .p2align 3
    v_lshlrev_b32_e64 v134, 16, v202
    v_and_b32 v184, 0xffff0000, v202
    v_mul_f32 v134, 0x3fb8aa3b, v134
    v_mul_f32 v184, 0x3fb8aa3b, v184
    v_exp_f32_e64 v134, v134
    v_exp_f32_e64 v184, v184
    v_cvt_pk_bf16_f32 v134, v134, v134
    v_lshlrev_b32_e64 v135, 16, v203
    v_cvt_pk_bf16_f32 v184, v184, v184
    v_and_b32 v185, 0xffff0000, v203
    v_lshlrev_b32_e64 v136, 16, v204
    v_lshlrev_b32_e64 v137, 16, v205
    v_add_f32_e64 v118, v15, v15
    v_and_b32 v186, 0xffff0000, v204
    v_and_b32 v187, 0xffff0000, v205
    v_add_f32_e64 v168, v15, v15
    v_mul_f32_e64 v119, v15, v135
    v_lshlrev_b32_e64 v134, 16, v134
    v_mul_f32_e64 v169, v15, v185
    v_lshlrev_b32_e64 v184, 16, v184
    v_mul_f32_e64 v102, v118, v136
    v_mul_f32_e64 v103, v118, v137
    v_mul_f32_e64 v152, v168, v186
    v_mul_f32_e64 v153, v168, v187
    v_mul_f32 v119, 0x3e22f983, v119
    v_mul_f32_e64 v118, v15, v134
    v_mul_f32 v169, 0x3e22f983, v169
    v_mul_f32_e64 v168, v15, v184
    v_mul_f32 v118, 0xbfb8aa3b, v118
    v_mul_f32 v121, 0x41000000, v119
    v_mul_f32 v168, 0xbfb8aa3b, v168
    v_mul_f32 v171, 0x41000000, v169
    v_mul_f32 v120, 0x41000000, v118
    v_fract_f32_e64 v121, v121
    v_mul_f32 v170, 0x41000000, v168
    v_fract_f32_e64 v171, v171
    v_exp_f32_e64 v120, v120
    v_cos_f32_e64 v94, v121
    v_sin_f32_e64 v95, v121
    v_exp_f32_e64 v170, v170
    v_cos_f32_e64 v144, v171
    v_sin_f32_e64 v145, v171
    v_mul_f32_e64 v94, v120, v94
    v_mul_f32_e64 v95, -v120, v95
    v_mul_f32_e64 v144, v170, v144
    v_mul_f32_e64 v145, -v170, v145
    v_pk_mul_f32 v[96:97], v[94:95], v[94:95] op_sel:[0,0] op_sel_hi:[1,0]
    v_pk_mul_f32 v[146:147], v[144:145], v[144:145] op_sel:[0,0] op_sel_hi:[1,0]
    v_pk_fma_f32 v[96:97], v[94:95], v[94:95], v[96:97] op_sel:[1,1,0] op_sel_hi:[0,1,1] neg_lo:[0,1,0]
    v_pk_fma_f32 v[146:147], v[144:145], v[144:145], v[146:147] op_sel:[1,1,0] op_sel_hi:[0,1,1] neg_lo:[0,1,0]
    v_pk_mul_f32 v[136:137], v[94:95], v[96:97] op_sel:[0,0] op_sel_hi:[1,0]
    v_pk_mul_f32 v[186:187], v[144:145], v[146:147] op_sel:[0,0] op_sel_hi:[1,0]
    v_pk_fma_f32 v[136:137], v[94:95], v[96:97], v[136:137] op_sel:[1,1,0] op_sel_hi:[0,1,1] neg_lo:[0,1,0]
    v_pk_fma_f32 v[186:187], v[144:145], v[146:147], v[186:187] op_sel:[1,1,0] op_sel_hi:[0,1,1] neg_lo:[0,1,0]
    v_pk_mul_f32 v[134:135], v[96:97], v[96:97] op_sel:[0,0] op_sel_hi:[1,0]
    v_pk_mul_f32 v[184:185], v[146:147], v[146:147] op_sel:[0,0] op_sel_hi:[1,0]
    v_pk_mul_f32 v[140:141], v[136:137], v[96:97] op_sel:[0,0] op_sel_hi:[1,0]
    v_pk_mul_f32 v[190:191], v[186:187], v[146:147] op_sel:[0,0] op_sel_hi:[1,0]
    v_pk_fma_f32 v[134:135], v[96:97], v[96:97], v[134:135] op_sel:[1,1,0] op_sel_hi:[0,1,1] neg_lo:[0,1,0]
    v_pk_fma_f32 v[184:185], v[146:147], v[146:147], v[184:185] op_sel:[1,1,0] op_sel_hi:[0,1,1] neg_lo:[0,1,0]
    v_pk_fma_f32 v[140:141], v[136:137], v[96:97], v[140:141] op_sel:[1,1,0] op_sel_hi:[0,1,1] neg_lo:[0,1,0]
    v_pk_fma_f32 v[190:191], v[186:187], v[146:147], v[190:191] op_sel:[1,1,0] op_sel_hi:[0,1,1] neg_lo:[0,1,0]
    v_pk_mul_f32 v[138:139], v[134:135], v[96:97] op_sel:[0,0] op_sel_hi:[1,0]
    v_pk_mul_f32 v[188:189], v[184:185], v[146:147] op_sel:[0,0] op_sel_hi:[1,0]
    v_cvt_pk_bf16_f32 v82, v136, v137
    v_cvt_pk_bf16_f32 v83, v186, v187
    v_pk_mul_f32 v[136:137], v[140:141], v[96:97] op_sel:[0,0] op_sel_hi:[1,0]
    v_pk_mul_f32 v[186:187], v[190:191], v[146:147] op_sel:[0,0] op_sel_hi:[1,0]
    v_pk_fma_f32 v[138:139], v[134:135], v[96:97], v[138:139] op_sel:[1,1,0] op_sel_hi:[0,1,1] neg_lo:[0,1,0]
    v_pk_fma_f32 v[188:189], v[184:185], v[146:147], v[188:189] op_sel:[1,1,0] op_sel_hi:[0,1,1] neg_lo:[0,1,0]
    v_cvt_pk_bf16_f32 v84, v134, v135
    v_cvt_pk_bf16_f32 v85, v184, v185
    v_pk_fma_f32 v[136:137], v[140:141], v[96:97], v[136:137] op_sel:[1,1,0] op_sel_hi:[0,1,1] neg_lo:[0,1,0]
    v_pk_fma_f32 v[186:187], v[190:191], v[146:147], v[186:187] op_sel:[1,1,0] op_sel_hi:[0,1,1] neg_lo:[0,1,0]
    v_mov_b32 v76, 0x3f80
    v_mov_b32 v77, 0x3f80
    v_pk_mul_f32 v[134:135], v[138:139], v[96:97] op_sel:[0,0] op_sel_hi:[1,0]
    v_pk_mul_f32 v[184:185], v[188:189], v[146:147] op_sel:[0,0] op_sel_hi:[1,0]
    v_cvt_pk_bf16_f32 v78, v94, v95
    v_cvt_pk_bf16_f32 v79, v144, v145
    v_cvt_pk_bf16_f32 v86, v140, v141
    v_cvt_pk_bf16_f32 v87, v190, v191
    v_fract_f32_e64 v123, v119
    v_fract_f32_e64 v173, v169
    ds_write_b64 v10, v[76:77] offset:0
    v_pk_mul_f32 v[140:141], v[136:137], v[96:97] op_sel:[0,0] op_sel_hi:[1,0]
    v_pk_mul_f32 v[190:191], v[186:187], v[146:147] op_sel:[0,0] op_sel_hi:[1,0]
    v_cvt_pk_bf16_f32 v80, v96, v97
    v_cvt_pk_bf16_f32 v81, v146, v147
    v_exp_f32_e64 v122, v118
    v_cos_f32_e64 v92, v123
    v_sin_f32_e64 v93, v123
    v_exp_f32_e64 v172, v168
    v_cos_f32_e64 v142, v173
    v_sin_f32_e64 v143, v173
    v_pk_fma_f32 v[134:135], v[138:139], v[96:97], v[134:135] op_sel:[1,1,0] op_sel_hi:[0,1,1] neg_lo:[0,1,0]
    v_pk_fma_f32 v[184:185], v[188:189], v[146:147], v[184:185] op_sel:[1,1,0] op_sel_hi:[0,1,1] neg_lo:[0,1,0]
    ds_write_b64 v10, v[78:79] offset:544
    v_cvt_pk_bf16_f32 v88, v138, v139
    v_cvt_pk_bf16_f32 v89, v188, v189
    v_pk_fma_f32 v[140:141], v[136:137], v[96:97], v[140:141] op_sel:[1,1,0] op_sel_hi:[0,1,1] neg_lo:[0,1,0]
    v_pk_fma_f32 v[190:191], v[186:187], v[146:147], v[190:191] op_sel:[1,1,0] op_sel_hi:[0,1,1] neg_lo:[0,1,0]
    ds_write_b64 v10, v[80:81] offset:1088
    v_pk_mul_f32 v[138:139], v[134:135], v[96:97] op_sel:[0,0] op_sel_hi:[1,0]
    v_pk_mul_f32 v[188:189], v[184:185], v[146:147] op_sel:[0,0] op_sel_hi:[1,0]
    v_cvt_pk_bf16_f32 v90, v136, v137
    v_cvt_pk_bf16_f32 v91, v186, v187
    ds_write_b64 v10, v[82:83] offset:1632
    v_mul_f32_e64 v92, v122, v92
    v_mul_f32_e64 v93, v122, v93
    v_mul_f32_e64 v142, v172, v142
    v_mul_f32_e64 v143, v172, v143
    v_pk_mul_f32 v[136:137], v[140:141], v[96:97] op_sel:[0,0] op_sel_hi:[1,0]
    v_pk_mul_f32 v[186:187], v[190:191], v[146:147] op_sel:[0,0] op_sel_hi:[1,0]
    ds_write_b64 v10, v[84:85] offset:2176
    v_pk_fma_f32 v[138:139], v[134:135], v[96:97], v[138:139] op_sel:[1,1,0] op_sel_hi:[0,1,1] neg_lo:[0,1,0]
    v_pk_fma_f32 v[188:189], v[184:185], v[146:147], v[188:189] op_sel:[1,1,0] op_sel_hi:[0,1,1] neg_lo:[0,1,0]
    v_pk_mul_f32 v[104:105], v[102:103], v[92:93] op_sel:[0,0] op_sel_hi:[1,0]
    v_pk_mul_f32 v[154:155], v[152:153], v[142:143] op_sel:[0,0] op_sel_hi:[1,0]
    ds_write_b64 v10, v[86:87] offset:2720
    v_cvt_pk_bf16_f32 v76, v134, v135
    v_cvt_pk_bf16_f32 v77, v184, v185
    v_pk_fma_f32 v[136:137], v[140:141], v[96:97], v[136:137] op_sel:[1,1,0] op_sel_hi:[0,1,1] neg_lo:[0,1,0]
    v_pk_fma_f32 v[186:187], v[190:191], v[146:147], v[186:187] op_sel:[1,1,0] op_sel_hi:[0,1,1] neg_lo:[0,1,0]
    v_pk_mul_f32 v[134:135], v[138:139], v[96:97] op_sel:[0,0] op_sel_hi:[1,0]
    v_pk_mul_f32 v[184:185], v[188:189], v[146:147] op_sel:[0,0] op_sel_hi:[1,0]
    v_pk_fma_f32 v[104:105], v[102:103], v[92:93], v[104:105] op_sel:[1,1,0] op_sel_hi:[0,1,1] neg_lo:[0,1,0]
    v_pk_fma_f32 v[154:155], v[152:153], v[142:143], v[154:155] op_sel:[1,1,0] op_sel_hi:[0,1,1] neg_lo:[0,1,0]
    ds_write_b64 v10, v[88:89] offset:3264
    v_cvt_pk_bf16_f32 v78, v140, v141
    v_cvt_pk_bf16_f32 v79, v190, v191
    v_pk_mul_f32 v[140:141], v[136:137], v[96:97] op_sel:[0,0] op_sel_hi:[1,0]
    v_pk_mul_f32 v[190:191], v[186:187], v[146:147] op_sel:[0,0] op_sel_hi:[1,0]
    ds_write_b64 v10, v[90:91] offset:3808
    v_pk_fma_f32 v[134:135], v[138:139], v[96:97], v[134:135] op_sel:[1,1,0] op_sel_hi:[0,1,1] neg_lo:[0,1,0]
    v_pk_fma_f32 v[184:185], v[188:189], v[146:147], v[184:185] op_sel:[1,1,0] op_sel_hi:[0,1,1] neg_lo:[0,1,0]
    v_pk_mul_f32 v[106:107], v[104:105], v[92:93] op_sel:[0,0] op_sel_hi:[1,0]
    v_pk_mul_f32 v[156:157], v[154:155], v[142:143] op_sel:[0,0] op_sel_hi:[1,0]
    ds_write_b64 v10, v[76:77] offset:4352
    v_cvt_pk_bf16_f32 v80, v138, v139
    v_cvt_pk_bf16_f32 v81, v188, v189
    v_pk_fma_f32 v[140:141], v[136:137], v[96:97], v[140:141] op_sel:[1,1,0] op_sel_hi:[0,1,1] neg_lo:[0,1,0]
    v_pk_fma_f32 v[190:191], v[186:187], v[146:147], v[190:191] op_sel:[1,1,0] op_sel_hi:[0,1,1] neg_lo:[0,1,0]
    ds_write_b64 v10, v[78:79] offset:4896
    v_pk_mul_f32 v[138:139], v[134:135], v[96:97] op_sel:[0,0] op_sel_hi:[1,0]
    v_pk_mul_f32 v[188:189], v[184:185], v[146:147] op_sel:[0,0] op_sel_hi:[1,0]
    v_pk_fma_f32 v[106:107], v[104:105], v[92:93], v[106:107] op_sel:[1,1,0] op_sel_hi:[0,1,1] neg_lo:[0,1,0]
    v_pk_fma_f32 v[156:157], v[154:155], v[142:143], v[156:157] op_sel:[1,1,0] op_sel_hi:[0,1,1] neg_lo:[0,1,0]
    v_cvt_pk_bf16_f32 v82, v136, v137
    v_cvt_pk_bf16_f32 v83, v186, v187
    ds_write_b64 v10, v[80:81] offset:5440
    v_pk_mul_f32 v[136:137], v[140:141], v[96:97] op_sel:[0,0] op_sel_hi:[1,0]
    v_pk_mul_f32 v[186:187], v[190:191], v[146:147] op_sel:[0,0] op_sel_hi:[1,0]
    v_cvt_pk_bf16_f32 v84, v134, v135
    v_cvt_pk_bf16_f32 v85, v184, v185
    v_pk_fma_f32 v[138:139], v[134:135], v[96:97], v[138:139] op_sel:[1,1,0] op_sel_hi:[0,1,1] neg_lo:[0,1,0]
    v_pk_fma_f32 v[188:189], v[184:185], v[146:147], v[188:189] op_sel:[1,1,0] op_sel_hi:[0,1,1] neg_lo:[0,1,0]
    v_pk_mul_f32 v[108:109], v[106:107], v[92:93] op_sel:[0,0] op_sel_hi:[1,0]
    v_pk_mul_f32 v[158:159], v[156:157], v[142:143] op_sel:[0,0] op_sel_hi:[1,0]
    ds_write_b64 v10, v[82:83] offset:5984
    v_cvt_pk_bf16_f32 v86, v140, v141
    v_cvt_pk_bf16_f32 v87, v190, v191
    v_pk_fma_f32 v[136:137], v[140:141], v[96:97], v[136:137] op_sel:[1,1,0] op_sel_hi:[0,1,1] neg_lo:[0,1,0]
    v_pk_fma_f32 v[186:187], v[190:191], v[146:147], v[186:187] op_sel:[1,1,0] op_sel_hi:[0,1,1] neg_lo:[0,1,0]
    ds_write_b64 v10, v[84:85] offset:6528
    v_cvt_pk_bf16_f32 v88, v138, v139
    v_cvt_pk_bf16_f32 v89, v188, v189
    v_pk_fma_f32 v[108:109], v[106:107], v[92:93], v[108:109] op_sel:[1,1,0] op_sel_hi:[0,1,1] neg_lo:[0,1,0]
    v_pk_fma_f32 v[158:159], v[156:157], v[142:143], v[158:159] op_sel:[1,1,0] op_sel_hi:[0,1,1] neg_lo:[0,1,0]
    ds_write_b64 v10, v[86:87] offset:7072
    v_cvt_pk_bf16_f32 v90, v136, v137
    v_cvt_pk_bf16_f32 v91, v186, v187
    ds_write_b64 v10, v[88:89] offset:7616
    v_pk_mul_f32 v[110:111], v[108:109], v[92:93] op_sel:[0,0] op_sel_hi:[1,0]
    v_pk_mul_f32 v[160:161], v[158:159], v[142:143] op_sel:[0,0] op_sel_hi:[1,0]
    ds_write_b64 v10, v[90:91] offset:8160
    v_pk_fma_f32 v[110:111], v[108:109], v[92:93], v[110:111] op_sel:[1,1,0] op_sel_hi:[0,1,1] neg_lo:[0,1,0]
    v_pk_fma_f32 v[160:161], v[158:159], v[142:143], v[160:161] op_sel:[1,1,0] op_sel_hi:[0,1,1] neg_lo:[0,1,0]
    ds_read_b128 v[28:31], v2 offset:0
    ds_read_b128 v[32:35], v2 offset:64
    v_pk_mul_f32 v[112:113], v[110:111], v[92:93] op_sel:[0,0] op_sel_hi:[1,0]
    v_pk_mul_f32 v[162:163], v[160:161], v[142:143] op_sel:[0,0] op_sel_hi:[1,0]
    ds_read_b128 v[36:39], v2 offset:128
    ds_read_b128 v[40:43], v2 offset:192
    ds_read_b128 v[44:47], v2 offset:256
    v_pk_fma_f32 v[112:113], v[110:111], v[92:93], v[112:113] op_sel:[1,1,0] op_sel_hi:[0,1,1] neg_lo:[0,1,0]
    v_pk_fma_f32 v[162:163], v[160:161], v[142:143], v[162:163] op_sel:[1,1,0] op_sel_hi:[0,1,1] neg_lo:[0,1,0]
    v_mul_f32 v125, 0x43000000, v119
    v_mul_f32 v175, 0x43000000, v169
    ds_read_b128 v[48:51], v2 offset:320
    v_mul_f32 v124, 0x43000000, v118
    v_fract_f32_e64 v125, v125
    v_mul_f32 v174, 0x43000000, v168
    v_fract_f32_e64 v175, v175
    v_cvt_pk_bf16_f32 v76, v102, v103
    v_cvt_pk_bf16_f32 v77, v152, v153
    ds_read_b128 v[52:55], v2 offset:384
    v_pk_mul_f32 v[114:115], v[112:113], v[92:93] op_sel:[0,0] op_sel_hi:[1,0]
    v_pk_mul_f32 v[164:165], v[162:163], v[142:143] op_sel:[0,0] op_sel_hi:[1,0]
    ds_read_b128 v[56:59], v2 offset:448
    v_cvt_pk_bf16_f32 v78, v104, v105
    v_cvt_pk_bf16_f32 v79, v154, v155
    v_exp_f32_e64 v124, v124
    v_cos_f32_e64 v98, v125
    v_sin_f32_e64 v99, v125
    v_exp_f32_e64 v174, v174
    v_cos_f32_e64 v148, v175
    v_sin_f32_e64 v149, v175
    ds_write_b64 v10, v[76:77] offset:0
    v_pk_fma_f32 v[114:115], v[112:113], v[92:93], v[114:115] op_sel:[1,1,0] op_sel_hi:[0,1,1] neg_lo:[0,1,0]
    v_pk_fma_f32 v[164:165], v[162:163], v[142:143], v[164:165] op_sel:[1,1,0] op_sel_hi:[0,1,1] neg_lo:[0,1,0]
    v_cvt_pk_bf16_f32 v80, v106, v107
    v_cvt_pk_bf16_f32 v81, v156, v157
    ds_write_b64 v10, v[78:79] offset:544
    v_cvt_pk_bf16_f32 v82, v108, v109
    v_cvt_pk_bf16_f32 v83, v158, v159
    v_mul_f32_e64 v98, v124, v98
    v_mul_f32_e64 v99, v124, v99
    v_mul_f32_e64 v148, v174, v148
    v_mul_f32_e64 v149, v174, v149
    v_pk_mul_f32 v[116:117], v[114:115], v[92:93] op_sel:[0,0] op_sel_hi:[1,0]
    v_pk_mul_f32 v[166:167], v[164:165], v[142:143] op_sel:[0,0] op_sel_hi:[1,0]
    ds_write_b64 v10, v[80:81] offset:1088
    v_cvt_pk_bf16_f32 v84, v110, v111
    v_cvt_pk_bf16_f32 v85, v160, v161
    v_pk_mul_f32 v[118:119], v[102:103], v[98:99] op_sel:[0,0] op_sel_hi:[1,0]
    v_pk_mul_f32 v[168:169], v[152:153], v[148:149] op_sel:[0,0] op_sel_hi:[1,0]
    ds_write_b64 v10, v[82:83] offset:1632
    v_cvt_pk_bf16_f32 v86, v112, v113
    v_cvt_pk_bf16_f32 v87, v162, v163
    v_pk_fma_f32 v[116:117], v[114:115], v[92:93], v[116:117] op_sel:[1,1,0] op_sel_hi:[0,1,1] neg_lo:[0,1,0]
    v_pk_fma_f32 v[166:167], v[164:165], v[142:143], v[166:167] op_sel:[1,1,0] op_sel_hi:[0,1,1] neg_lo:[0,1,0]
    v_pk_mul_f32 v[120:121], v[104:105], v[98:99] op_sel:[0,0] op_sel_hi:[1,0]
    v_pk_mul_f32 v[170:171], v[154:155], v[148:149] op_sel:[0,0] op_sel_hi:[1,0]
    ds_write_b64 v10, v[84:85] offset:2176
    v_cvt_pk_bf16_f32 v88, v114, v115
    v_cvt_pk_bf16_f32 v89, v164, v165
    v_pk_fma_f32 v[118:119], v[102:103], v[98:99], v[118:119] op_sel:[1,1,0] op_sel_hi:[0,1,1] neg_lo:[0,1,0]
    v_pk_fma_f32 v[168:169], v[152:153], v[148:149], v[168:169] op_sel:[1,1,0] op_sel_hi:[0,1,1] neg_lo:[0,1,0]
    v_pk_mul_f32 v[122:123], v[106:107], v[98:99] op_sel:[0,0] op_sel_hi:[1,0]
    v_pk_mul_f32 v[172:173], v[156:157], v[148:149] op_sel:[0,0] op_sel_hi:[1,0]
    ds_write_b64 v10, v[86:87] offset:2720
    v_cvt_pk_bf16_f32 v90, v116, v117
    v_cvt_pk_bf16_f32 v91, v166, v167
    v_pk_fma_f32 v[120:121], v[104:105], v[98:99], v[120:121] op_sel:[1,1,0] op_sel_hi:[0,1,1] neg_lo:[0,1,0]
    v_pk_fma_f32 v[170:171], v[154:155], v[148:149], v[170:171] op_sel:[1,1,0] op_sel_hi:[0,1,1] neg_lo:[0,1,0]
    v_pk_mul_f32 v[124:125], v[108:109], v[98:99] op_sel:[0,0] op_sel_hi:[1,0]
    v_pk_mul_f32 v[174:175], v[158:159], v[148:149] op_sel:[0,0] op_sel_hi:[1,0]
    ds_write_b64 v10, v[88:89] offset:3264
    v_cvt_pk_bf16_f32 v76, v118, v119
    v_cvt_pk_bf16_f32 v77, v168, v169
    v_pk_fma_f32 v[122:123], v[106:107], v[98:99], v[122:123] op_sel:[1,1,0] op_sel_hi:[0,1,1] neg_lo:[0,1,0]
    v_pk_fma_f32 v[172:173], v[156:157], v[148:149], v[172:173] op_sel:[1,1,0] op_sel_hi:[0,1,1] neg_lo:[0,1,0]
    v_pk_mul_f32 v[126:127], v[110:111], v[98:99] op_sel:[0,0] op_sel_hi:[1,0]
    v_pk_mul_f32 v[176:177], v[160:161], v[148:149] op_sel:[0,0] op_sel_hi:[1,0]
    ds_write_b64 v10, v[90:91] offset:3808
    v_cvt_pk_bf16_f32 v78, v120, v121
    v_cvt_pk_bf16_f32 v79, v170, v171
    v_pk_fma_f32 v[124:125], v[108:109], v[98:99], v[124:125] op_sel:[1,1,0] op_sel_hi:[0,1,1] neg_lo:[0,1,0]
    v_pk_fma_f32 v[174:175], v[158:159], v[148:149], v[174:175] op_sel:[1,1,0] op_sel_hi:[0,1,1] neg_lo:[0,1,0]
    v_pk_mul_f32 v[128:129], v[112:113], v[98:99] op_sel:[0,0] op_sel_hi:[1,0]
    v_pk_mul_f32 v[178:179], v[162:163], v[148:149] op_sel:[0,0] op_sel_hi:[1,0]
    ds_write_b64 v10, v[76:77] offset:4352
    v_cvt_pk_bf16_f32 v80, v122, v123
    v_cvt_pk_bf16_f32 v81, v172, v173
    v_pk_fma_f32 v[126:127], v[110:111], v[98:99], v[126:127] op_sel:[1,1,0] op_sel_hi:[0,1,1] neg_lo:[0,1,0]
    v_pk_fma_f32 v[176:177], v[160:161], v[148:149], v[176:177] op_sel:[1,1,0] op_sel_hi:[0,1,1] neg_lo:[0,1,0]
    ds_write_b64 v10, v[78:79] offset:4896
    v_cvt_pk_bf16_f32 v82, v124, v125
    v_cvt_pk_bf16_f32 v83, v174, v175
    v_pk_mul_f32 v[130:131], v[114:115], v[98:99] op_sel:[0,0] op_sel_hi:[1,0]
    v_pk_mul_f32 v[180:181], v[164:165], v[148:149] op_sel:[0,0] op_sel_hi:[1,0]
    v_pk_fma_f32 v[128:129], v[112:113], v[98:99], v[128:129] op_sel:[1,1,0] op_sel_hi:[0,1,1] neg_lo:[0,1,0]
    v_pk_fma_f32 v[178:179], v[162:163], v[148:149], v[178:179] op_sel:[1,1,0] op_sel_hi:[0,1,1] neg_lo:[0,1,0]
    ds_write_b64 v10, v[80:81] offset:5440
    v_cvt_pk_bf16_f32 v84, v126, v127
    v_cvt_pk_bf16_f32 v85, v176, v177
    v_pk_mul_f32 v[132:133], v[116:117], v[98:99] op_sel:[0,0] op_sel_hi:[1,0]
    v_pk_mul_f32 v[182:183], v[166:167], v[148:149] op_sel:[0,0] op_sel_hi:[1,0]
    ds_write_b64 v10, v[82:83] offset:5984
    v_pk_fma_f32 v[130:131], v[114:115], v[98:99], v[130:131] op_sel:[1,1,0] op_sel_hi:[0,1,1] neg_lo:[0,1,0]
    v_pk_fma_f32 v[180:181], v[164:165], v[148:149], v[180:181] op_sel:[1,1,0] op_sel_hi:[0,1,1] neg_lo:[0,1,0]
    v_cvt_pk_bf16_f32 v86, v128, v129
    v_cvt_pk_bf16_f32 v87, v178, v179
    ds_write_b64 v10, v[84:85] offset:6528
    v_pk_fma_f32 v[132:133], v[116:117], v[98:99], v[132:133] op_sel:[1,1,0] op_sel_hi:[0,1,1] neg_lo:[0,1,0]
    v_pk_fma_f32 v[182:183], v[166:167], v[148:149], v[182:183] op_sel:[1,1,0] op_sel_hi:[0,1,1] neg_lo:[0,1,0]
    v_cvt_pk_bf16_f32 v88, v130, v131
    v_cvt_pk_bf16_f32 v89, v180, v181
    ds_write_b64 v10, v[86:87] offset:7072
    v_cvt_pk_bf16_f32 v90, v132, v133
    v_cvt_pk_bf16_f32 v91, v182, v183
    buffer_load_dwordx4 v[214:217], v5, s[44:47], s59 offen offset:0
    ds_write_b64 v10, v[88:89] offset:7616
    ds_write_b64 v10, v[90:91] offset:8160
    buffer_load_dwordx4 v[218:221], v5, s[44:47], s59 offen offset:1152
    ds_read_b128 v[60:63], v2 offset:0
    ds_read_b128 v[64:67], v2 offset:64
    ds_read_b128 v[68:71], v2 offset:128
    ds_read_b128 v[72:75], v2 offset:192
    v_pk_mul_f32 v[100:101], v[98:99], v[98:99] op_sel:[0,0] op_sel_hi:[1,0]
    v_pk_mul_f32 v[150:151], v[148:149], v[148:149] op_sel:[0,0] op_sel_hi:[1,0]
    v_pk_fma_f32 v[100:101], v[98:99], v[98:99], v[100:101] op_sel:[1,1,0] op_sel_hi:[0,1,1] neg_lo:[0,1,0]
    v_pk_fma_f32 v[150:151], v[148:149], v[148:149], v[150:151] op_sel:[1,1,0] op_sel_hi:[0,1,1] neg_lo:[0,1,0]
    v_pk_mul_f32 v[104:105], v[102:103], v[100:101] op_sel:[0,0] op_sel_hi:[1,0]
    v_pk_mul_f32 v[154:155], v[152:153], v[150:151] op_sel:[0,0] op_sel_hi:[1,0]
    v_pk_mul_f32 v[108:109], v[106:107], v[100:101] op_sel:[0,0] op_sel_hi:[1,0]
    v_pk_mul_f32 v[158:159], v[156:157], v[150:151] op_sel:[0,0] op_sel_hi:[1,0]
    v_pk_fma_f32 v[104:105], v[102:103], v[100:101], v[104:105] op_sel:[1,1,0] op_sel_hi:[0,1,1] neg_lo:[0,1,0]
    v_pk_fma_f32 v[154:155], v[152:153], v[150:151], v[154:155] op_sel:[1,1,0] op_sel_hi:[0,1,1] neg_lo:[0,1,0]
    v_pk_mul_f32 v[112:113], v[110:111], v[100:101] op_sel:[0,0] op_sel_hi:[1,0]
    v_pk_mul_f32 v[162:163], v[160:161], v[150:151] op_sel:[0,0] op_sel_hi:[1,0]
    v_pk_fma_f32 v[108:109], v[106:107], v[100:101], v[108:109] op_sel:[1,1,0] op_sel_hi:[0,1,1] neg_lo:[0,1,0]
    v_pk_fma_f32 v[158:159], v[156:157], v[150:151], v[158:159] op_sel:[1,1,0] op_sel_hi:[0,1,1] neg_lo:[0,1,0]
    v_pk_mul_f32 v[116:117], v[114:115], v[100:101] op_sel:[0,0] op_sel_hi:[1,0]
    v_pk_mul_f32 v[166:167], v[164:165], v[150:151] op_sel:[0,0] op_sel_hi:[1,0]
    v_cvt_pk_bf16_f32 v76, v104, v105
    v_cvt_pk_bf16_f32 v77, v154, v155
    v_pk_fma_f32 v[112:113], v[110:111], v[100:101], v[112:113] op_sel:[1,1,0] op_sel_hi:[0,1,1] neg_lo:[0,1,0]
    v_pk_fma_f32 v[162:163], v[160:161], v[150:151], v[162:163] op_sel:[1,1,0] op_sel_hi:[0,1,1] neg_lo:[0,1,0]
    v_cvt_pk_bf16_f32 v78, v108, v109
    v_cvt_pk_bf16_f32 v79, v158, v159
    s_waitcnt lgkmcnt(3)
    s_nop 0
    v_mfma_f32_16x16x32_bf16 v[16:19], v[60:63], v[28:31], 0
    s_waitcnt lgkmcnt(2)
    s_nop 0
    v_mfma_f32_16x16x32_bf16 v[16:19], v[64:67], v[32:35], v[16:19]
    s_waitcnt lgkmcnt(1)
    s_nop 0
    v_mfma_f32_16x16x32_bf16 v[16:19], v[68:71], v[36:39], v[16:19]
    ds_read_b128 v[60:63], v2 offset:256
    ds_read_b128 v[64:67], v2 offset:320
    s_waitcnt lgkmcnt(2)
    s_nop 0
    v_mfma_f32_16x16x32_bf16 v[16:19], v[72:75], v[40:43], v[16:19]
    ds_read_b128 v[68:71], v2 offset:384
    ds_read_b128 v[72:75], v2 offset:448
    buffer_load_dwordx4 v[222:225], v5, s[44:47], s59 offen offset:2304
    v_pk_mul_f32 v[120:121], v[118:119], v[100:101] op_sel:[0,0] op_sel_hi:[1,0]
    v_pk_mul_f32 v[170:171], v[168:169], v[150:151] op_sel:[0,0] op_sel_hi:[1,0]
    v_pk_fma_f32 v[116:117], v[114:115], v[100:101], v[116:117] op_sel:[1,1,0] op_sel_hi:[0,1,1] neg_lo:[0,1,0]
    v_pk_fma_f32 v[166:167], v[164:165], v[150:151], v[166:167] op_sel:[1,1,0] op_sel_hi:[0,1,1] neg_lo:[0,1,0]
    ds_write_b64 v10, v[76:77] offset:0
    v_cvt_pk_bf16_f32 v80, v112, v113
    v_cvt_pk_bf16_f32 v81, v162, v163
    v_pk_mul_f32 v[124:125], v[122:123], v[100:101] op_sel:[0,0] op_sel_hi:[1,0]
    v_pk_mul_f32 v[174:175], v[172:173], v[150:151] op_sel:[0,0] op_sel_hi:[1,0]
    ds_write_b64 v10, v[78:79] offset:544
    v_pk_fma_f32 v[120:121], v[118:119], v[100:101], v[120:121] op_sel:[1,1,0] op_sel_hi:[0,1,1] neg_lo:[0,1,0]
    v_pk_fma_f32 v[170:171], v[168:169], v[150:151], v[170:171] op_sel:[1,1,0] op_sel_hi:[0,1,1] neg_lo:[0,1,0]
    v_cvt_pk_bf16_f32 v82, v116, v117
    v_cvt_pk_bf16_f32 v83, v166, v167
    v_pk_mul_f32 v[128:129], v[126:127], v[100:101] op_sel:[0,0] op_sel_hi:[1,0]
    v_pk_mul_f32 v[178:179], v[176:177], v[150:151] op_sel:[0,0] op_sel_hi:[1,0]
    ds_write_b64 v10, v[80:81] offset:1088
    v_pk_fma_f32 v[124:125], v[122:123], v[100:101], v[124:125] op_sel:[1,1,0] op_sel_hi:[0,1,1] neg_lo:[0,1,0]
    v_pk_fma_f32 v[174:175], v[172:173], v[150:151], v[174:175] op_sel:[1,1,0] op_sel_hi:[0,1,1] neg_lo:[0,1,0]
    v_pk_mul_f32 v[132:133], v[130:131], v[100:101] op_sel:[0,0] op_sel_hi:[1,0]
    v_pk_mul_f32 v[182:183], v[180:181], v[150:151] op_sel:[0,0] op_sel_hi:[1,0]
    v_cvt_pk_bf16_f32 v84, v120, v121
    v_cvt_pk_bf16_f32 v85, v170, v171
    ds_write_b64 v10, v[82:83] offset:1632
    v_pk_fma_f32 v[128:129], v[126:127], v[100:101], v[128:129] op_sel:[1,1,0] op_sel_hi:[0,1,1] neg_lo:[0,1,0]
    v_pk_fma_f32 v[178:179], v[176:177], v[150:151], v[178:179] op_sel:[1,1,0] op_sel_hi:[0,1,1] neg_lo:[0,1,0]
    v_pk_mul_f32 v[102:103], v[104:105], v[100:101] op_sel:[0,0] op_sel_hi:[1,0]
    v_pk_mul_f32 v[152:153], v[154:155], v[150:151] op_sel:[0,0] op_sel_hi:[1,0]
    v_cvt_pk_bf16_f32 v86, v124, v125
    v_cvt_pk_bf16_f32 v87, v174, v175
    buffer_load_dwordx4 v[226:229], v5, s[44:47], s59 offen offset:3456
    v_pk_fma_f32 v[132:133], v[130:131], v[100:101], v[132:133] op_sel:[1,1,0] op_sel_hi:[0,1,1] neg_lo:[0,1,0]
    v_pk_fma_f32 v[182:183], v[180:181], v[150:151], v[182:183] op_sel:[1,1,0] op_sel_hi:[0,1,1] neg_lo:[0,1,0]
    v_pk_mul_f32 v[106:107], v[112:113], v[100:101] op_sel:[0,0] op_sel_hi:[1,0]
    v_pk_mul_f32 v[156:157], v[162:163], v[150:151] op_sel:[0,0] op_sel_hi:[1,0]
    ds_write_b64 v10, v[84:85] offset:2176
    v_cvt_pk_bf16_f32 v88, v128, v129
    v_cvt_pk_bf16_f32 v89, v178, v179
    v_pk_fma_f32 v[102:103], v[104:105], v[100:101], v[102:103] op_sel:[1,1,0] op_sel_hi:[0,1,1] neg_lo:[0,1,0]
    v_pk_fma_f32 v[152:153], v[154:155], v[150:151], v[152:153] op_sel:[1,1,0] op_sel_hi:[0,1,1] neg_lo:[0,1,0]
    v_pk_mul_f32 v[110:111], v[120:121], v[100:101] op_sel:[0,0] op_sel_hi:[1,0]
    v_pk_mul_f32 v[160:161], v[170:171], v[150:151] op_sel:[0,0] op_sel_hi:[1,0]
    ds_write_b64 v10, v[86:87] offset:2720
    v_cvt_pk_bf16_f32 v90, v132, v133
    v_cvt_pk_bf16_f32 v91, v182, v183
    v_pk_fma_f32 v[106:107], v[112:113], v[100:101], v[106:107] op_sel:[1,1,0] op_sel_hi:[0,1,1] neg_lo:[0,1,0]
    v_pk_fma_f32 v[156:157], v[162:163], v[150:151], v[156:157] op_sel:[1,1,0] op_sel_hi:[0,1,1] neg_lo:[0,1,0]
    v_pk_mul_f32 v[114:115], v[128:129], v[100:101] op_sel:[0,0] op_sel_hi:[1,0]
    v_pk_mul_f32 v[164:165], v[178:179], v[150:151] op_sel:[0,0] op_sel_hi:[1,0]
    ds_write_b64 v10, v[88:89] offset:3264
    v_cvt_pk_bf16_f32 v76, v102, v103
    v_cvt_pk_bf16_f32 v77, v152, v153
    v_pk_fma_f32 v[110:111], v[120:121], v[100:101], v[110:111] op_sel:[1,1,0] op_sel_hi:[0,1,1] neg_lo:[0,1,0]
    v_pk_fma_f32 v[160:161], v[170:171], v[150:151], v[160:161] op_sel:[1,1,0] op_sel_hi:[0,1,1] neg_lo:[0,1,0]
    v_pk_mul_f32 v[118:119], v[102:103], v[100:101] op_sel:[0,0] op_sel_hi:[1,0]
    v_pk_mul_f32 v[168:169], v[152:153], v[150:151] op_sel:[0,0] op_sel_hi:[1,0]
    ds_write_b64 v10, v[90:91] offset:3808
    v_cvt_pk_bf16_f32 v78, v106, v107
    v_cvt_pk_bf16_f32 v79, v156, v157
    v_pk_fma_f32 v[114:115], v[128:129], v[100:101], v[114:115] op_sel:[1,1,0] op_sel_hi:[0,1,1] neg_lo:[0,1,0]
    v_pk_fma_f32 v[164:165], v[178:179], v[150:151], v[164:165] op_sel:[1,1,0] op_sel_hi:[0,1,1] neg_lo:[0,1,0]
    v_pk_mul_f32 v[122:123], v[106:107], v[100:101] op_sel:[0,0] op_sel_hi:[1,0]
    v_pk_mul_f32 v[172:173], v[156:157], v[150:151] op_sel:[0,0] op_sel_hi:[1,0]
    ds_write_b64 v10, v[76:77] offset:4352
    v_cvt_pk_bf16_f32 v80, v110, v111
    v_cvt_pk_bf16_f32 v81, v160, v161
    v_pk_fma_f32 v[118:119], v[102:103], v[100:101], v[118:119] op_sel:[1,1,0] op_sel_hi:[0,1,1] neg_lo:[0,1,0]
    v_pk_fma_f32 v[168:169], v[152:153], v[150:151], v[168:169] op_sel:[1,1,0] op_sel_hi:[0,1,1] neg_lo:[0,1,0]
    v_pk_mul_f32 v[126:127], v[110:111], v[100:101] op_sel:[0,0] op_sel_hi:[1,0]
    v_pk_mul_f32 v[176:177], v[160:161], v[150:151] op_sel:[0,0] op_sel_hi:[1,0]
    ds_write_b64 v10, v[78:79] offset:4896
    v_cvt_pk_bf16_f32 v82, v114, v115
    v_cvt_pk_bf16_f32 v83, v164, v165
    v_pk_fma_f32 v[122:123], v[106:107], v[100:101], v[122:123] op_sel:[1,1,0] op_sel_hi:[0,1,1] neg_lo:[0,1,0]
    v_pk_fma_f32 v[172:173], v[156:157], v[150:151], v[172:173] op_sel:[1,1,0] op_sel_hi:[0,1,1] neg_lo:[0,1,0]
    v_pk_mul_f32 v[130:131], v[114:115], v[100:101] op_sel:[0,0] op_sel_hi:[1,0]
    v_pk_mul_f32 v[180:181], v[164:165], v[150:151] op_sel:[0,0] op_sel_hi:[1,0]
    ds_write_b64 v10, v[80:81] offset:5440
    v_cvt_pk_bf16_f32 v84, v118, v119
    v_cvt_pk_bf16_f32 v85, v168, v169
    v_pk_fma_f32 v[126:127], v[110:111], v[100:101], v[126:127] op_sel:[1,1,0] op_sel_hi:[0,1,1] neg_lo:[0,1,0]
    v_pk_fma_f32 v[176:177], v[160:161], v[150:151], v[176:177] op_sel:[1,1,0] op_sel_hi:[0,1,1] neg_lo:[0,1,0]
    ds_write_b64 v10, v[82:83] offset:5984
    v_cvt_pk_bf16_f32 v86, v122, v123
    v_cvt_pk_bf16_f32 v87, v172, v173
    v_pk_fma_f32 v[130:131], v[114:115], v[100:101], v[130:131] op_sel:[1,1,0] op_sel_hi:[0,1,1] neg_lo:[0,1,0]
    v_pk_fma_f32 v[180:181], v[164:165], v[150:151], v[180:181] op_sel:[1,1,0] op_sel_hi:[0,1,1] neg_lo:[0,1,0]
    ds_write_b64 v10, v[84:85] offset:6528
    v_cvt_pk_bf16_f32 v88, v126, v127
    v_cvt_pk_bf16_f32 v89, v176, v177
    ds_write_b64 v10, v[86:87] offset:7072
    v_cvt_pk_bf16_f32 v90, v130, v131
    v_cvt_pk_bf16_f32 v91, v180, v181
    ds_write_b64 v10, v[88:89] offset:7616
    ds_write_b64 v10, v[90:91] offset:8160
    s_waitcnt lgkmcnt(15)
    s_nop 0
    v_mfma_f32_16x16x32_bf16 v[16:19], v[60:63], v[44:47], v[16:19]
    global_load_dword v235, v230, s[12:13]
    ds_read_b128 v[60:63], v2 offset:0
    s_waitcnt lgkmcnt(15)
    s_nop 0
    v_mfma_f32_16x16x32_bf16 v[16:19], v[64:67], v[48:51], v[16:19]
    ds_read_b128 v[64:67], v2 offset:64
    s_waitcnt lgkmcnt(15)
    s_nop 0
    v_mfma_f32_16x16x32_bf16 v[16:19], v[68:71], v[52:55], v[16:19]
    ds_read_b128 v[68:71], v2 offset:128
    s_waitcnt lgkmcnt(15)
    s_nop 0
    v_mfma_f32_16x16x32_bf16 v[16:19], v[72:75], v[56:59], v[16:19]
    ds_read_b128 v[72:75], v2 offset:192
    v_pk_mul_f32 v[134:135], v[118:119], v[100:101] op_sel:[0,0] op_sel_hi:[1,0]
    v_pk_mul_f32 v[184:185], v[168:169], v[150:151] op_sel:[0,0] op_sel_hi:[1,0]
    v_pk_fma_f32 v[134:135], v[118:119], v[100:101], v[134:135] op_sel:[1,1,0] op_sel_hi:[0,1,1] neg_lo:[0,1,0]
    v_pk_fma_f32 v[184:185], v[168:169], v[150:151], v[184:185] op_sel:[1,1,0] op_sel_hi:[0,1,1] neg_lo:[0,1,0]
    v_pk_mul_f32 v[136:137], v[126:127], v[100:101] op_sel:[0,0] op_sel_hi:[1,0]
    v_pk_mul_f32 v[186:187], v[176:177], v[150:151] op_sel:[0,0] op_sel_hi:[1,0]
    v_pk_mul_f32 v[138:139], v[134:135], v[100:101] op_sel:[0,0] op_sel_hi:[1,0]
    v_pk_mul_f32 v[188:189], v[184:185], v[150:151] op_sel:[0,0] op_sel_hi:[1,0]
    v_pk_fma_f32 v[136:137], v[126:127], v[100:101], v[136:137] op_sel:[1,1,0] op_sel_hi:[0,1,1] neg_lo:[0,1,0]
    v_pk_fma_f32 v[186:187], v[176:177], v[150:151], v[186:187] op_sel:[1,1,0] op_sel_hi:[0,1,1] neg_lo:[0,1,0]
    v_pk_fma_f32 v[138:139], v[134:135], v[100:101], v[138:139] op_sel:[1,1,0] op_sel_hi:[0,1,1] neg_lo:[0,1,0]
    v_pk_fma_f32 v[188:189], v[184:185], v[150:151], v[188:189] op_sel:[1,1,0] op_sel_hi:[0,1,1] neg_lo:[0,1,0]
    v_pk_mul_f32 v[140:141], v[136:137], v[100:101] op_sel:[0,0] op_sel_hi:[1,0]
    v_pk_mul_f32 v[190:191], v[186:187], v[150:151] op_sel:[0,0] op_sel_hi:[1,0]
    v_cvt_pk_bf16_f32 v76, v134, v135
    v_cvt_pk_bf16_f32 v77, v184, v185
    v_pk_mul_f32 v[134:135], v[138:139], v[100:101] op_sel:[0,0] op_sel_hi:[1,0]
    s_waitcnt lgkmcnt(3)
    s_nop 0
    v_mfma_f32_16x16x32_bf16 v[20:23], v[60:63], v[28:31], 0
    ds_read_b128 v[60:63], v2 offset:256
    s_waitcnt lgkmcnt(3)
    s_nop 0
    v_mfma_f32_16x16x32_bf16 v[20:23], v[64:67], v[32:35], v[20:23]
    ds_read_b128 v[64:67], v2 offset:320
    s_waitcnt lgkmcnt(3)
    s_nop 0
    v_mfma_f32_16x16x32_bf16 v[20:23], v[68:71], v[36:39], v[20:23]
    v_pk_mul_f32 v[184:185], v[188:189], v[150:151] op_sel:[0,0] op_sel_hi:[1,0]
    ds_read_b128 v[68:71], v2 offset:384
    v_pk_fma_f32 v[140:141], v[136:137], v[100:101], v[140:141] op_sel:[1,1,0] op_sel_hi:[0,1,1] neg_lo:[0,1,0]
    v_pk_fma_f32 v[190:191], v[186:187], v[150:151], v[190:191] op_sel:[1,1,0] op_sel_hi:[0,1,1] neg_lo:[0,1,0]
    s_waitcnt lgkmcnt(3)
    s_nop 0
    v_mfma_f32_16x16x32_bf16 v[20:23], v[72:75], v[40:43], v[20:23]
    v_cvt_pk_bf16_f32 v78, v136, v137
    v_cvt_pk_bf16_f32 v79, v186, v187
    v_pk_fma_f32 v[134:135], v[138:139], v[100:101], v[134:135] op_sel:[1,1,0] op_sel_hi:[0,1,1] neg_lo:[0,1,0]
    v_pk_fma_f32 v[184:185], v[188:189], v[150:151], v[184:185] op_sel:[1,1,0] op_sel_hi:[0,1,1] neg_lo:[0,1,0]
    ds_read_b128 v[72:75], v2 offset:448
    v_pk_mul_f32 v[136:137], v[140:141], v[100:101] op_sel:[0,0] op_sel_hi:[1,0]
    v_pk_mul_f32 v[186:187], v[190:191], v[150:151] op_sel:[0,0] op_sel_hi:[1,0]
    v_cvt_pk_bf16_f32 v80, v138, v139
    v_cvt_pk_bf16_f32 v81, v188, v189
    v_pk_mul_f32 v[138:139], v[134:135], v[100:101] op_sel:[0,0] op_sel_hi:[1,0]
    v_pk_mul_f32 v[188:189], v[184:185], v[150:151] op_sel:[0,0] op_sel_hi:[1,0]
    ds_write_b64 v10, v[76:77] offset:0
    v_pk_fma_f32 v[136:137], v[140:141], v[100:101], v[136:137] op_sel:[1,1,0] op_sel_hi:[0,1,1] neg_lo:[0,1,0]
    v_pk_fma_f32 v[186:187], v[190:191], v[150:151], v[186:187] op_sel:[1,1,0] op_sel_hi:[0,1,1] neg_lo:[0,1,0]
    ds_write_b64 v10, v[78:79] offset:544
    v_cvt_pk_bf16_f32 v82, v140, v141
    v_cvt_pk_bf16_f32 v83, v190, v191
    v_pk_fma_f32 v[138:139], v[134:135], v[100:101], v[138:139] op_sel:[1,1,0] op_sel_hi:[0,1,1] neg_lo:[0,1,0]
    v_pk_fma_f32 v[188:189], v[184:185], v[150:151], v[188:189] op_sel:[1,1,0] op_sel_hi:[0,1,1] neg_lo:[0,1,0]
    ds_write_b64 v10, v[80:81] offset:1088
    v_pk_mul_f32 v[140:141], v[136:137], v[100:101] op_sel:[0,0] op_sel_hi:[1,0]
    v_pk_mul_f32 v[190:191], v[186:187], v[150:151] op_sel:[0,0] op_sel_hi:[1,0]
    v_cvt_pk_bf16_f32 v84, v134, v135
    v_cvt_pk_bf16_f32 v85, v184, v185
    ds_write_b64 v10, v[82:83] offset:1632
    v_pk_mul_f32 v[134:135], v[138:139], v[100:101] op_sel:[0,0] op_sel_hi:[1,0]
    v_pk_mul_f32 v[184:185], v[188:189], v[150:151] op_sel:[0,0] op_sel_hi:[1,0]
    v_cvt_pk_bf16_f32 v86, v136, v137
    v_cvt_pk_bf16_f32 v87, v186, v187
    v_pk_fma_f32 v[140:141], v[136:137], v[100:101], v[140:141] op_sel:[1,1,0] op_sel_hi:[0,1,1] neg_lo:[0,1,0]
    v_pk_fma_f32 v[190:191], v[186:187], v[150:151], v[190:191] op_sel:[1,1,0] op_sel_hi:[0,1,1] neg_lo:[0,1,0]
    ds_write_b64 v10, v[84:85] offset:2176
    v_cvt_pk_bf16_f32 v88, v138, v139
    v_cvt_pk_bf16_f32 v89, v188, v189
    v_pk_fma_f32 v[134:135], v[138:139], v[100:101], v[134:135] op_sel:[1,1,0] op_sel_hi:[0,1,1] neg_lo:[0,1,0]
    v_pk_fma_f32 v[184:185], v[188:189], v[150:151], v[184:185] op_sel:[1,1,0] op_sel_hi:[0,1,1] neg_lo:[0,1,0]
    ds_write_b64 v10, v[86:87] offset:2720
    v_cvt_pk_bf16_f32 v90, v140, v141
    v_cvt_pk_bf16_f32 v91, v190, v191
    ds_write_b64 v10, v[88:89] offset:3264
    v_cvt_pk_bf16_f32 v76, v134, v135
    v_cvt_pk_bf16_f32 v77, v184, v185
    ds_write_b64 v10, v[90:91] offset:3808
    s_waitcnt lgkmcnt(11)
    s_nop 0
    v_mfma_f32_16x16x32_bf16 v[20:23], v[60:63], v[44:47], v[20:23]
    ds_write_b64 v10, v[76:77] offset:4352
    ds_read_b128 v[60:63], v2 offset:0
    s_waitcnt lgkmcnt(12)
    s_nop 0
    v_mfma_f32_16x16x32_bf16 v[20:23], v[64:67], v[48:51], v[20:23]
    ds_read_b128 v[64:67], v2 offset:64
    s_waitcnt lgkmcnt(12)
    s_nop 0
    v_mfma_f32_16x16x32_bf16 v[20:23], v[68:71], v[52:55], v[20:23]
    ds_read_b128 v[68:71], v2 offset:128
    s_waitcnt lgkmcnt(12)
    s_nop 0
    v_mfma_f32_16x16x32_bf16 v[20:23], v[72:75], v[56:59], v[20:23]
    ds_read_b128 v[72:75], v2 offset:192
    s_waitcnt lgkmcnt(3)
    s_nop 0
    v_mfma_f32_16x16x32_bf16 v[24:27], v[60:63], v[28:31], 0
    ds_read_b128 v[60:63], v2 offset:256
    s_waitcnt lgkmcnt(3)
    s_nop 0
    v_mfma_f32_16x16x32_bf16 v[24:27], v[64:67], v[32:35], v[24:27]
    ds_read_b128 v[64:67], v2 offset:320
    s_waitcnt lgkmcnt(3)
    s_nop 0
    v_mfma_f32_16x16x32_bf16 v[24:27], v[68:71], v[36:39], v[24:27]
    ds_read_b128 v[68:71], v2 offset:384
    s_waitcnt lgkmcnt(3)
    s_nop 0
    v_mfma_f32_16x16x32_bf16 v[24:27], v[72:75], v[40:43], v[24:27]
    ds_read_b128 v[72:75], v2 offset:448
    s_waitcnt lgkmcnt(3)
    s_nop 0
    v_mfma_f32_16x16x32_bf16 v[24:27], v[60:63], v[44:47], v[24:27]
    s_waitcnt lgkmcnt(2)
    s_nop 0
    v_mfma_f32_16x16x32_bf16 v[24:27], v[64:67], v[48:51], v[24:27]
    s_waitcnt lgkmcnt(1)
    s_nop 0
    v_mfma_f32_16x16x32_bf16 v[24:27], v[68:71], v[52:55], v[24:27]
    s_waitcnt lgkmcnt(0)
    s_nop 0
    v_mfma_f32_16x16x32_bf16 v[24:27], v[72:75], v[56:59], v[24:27]
    s_branch LA_expand
LA_kgy:
    .p2align 3
    v_lshlrev_b32 v139, 16, v202
    v_and_b32 v194, 0xffff0000, v202
    v_mul_f32 v139, 0x3fb8aa3b, v139
    v_mul_f32 v194, 0x3fb8aa3b, v194
    v_exp_f32 v139, v139
    v_exp_f32 v194, v194
    v_cvt_pk_bf16_f32 v139, v139, v139
    v_lshlrev_b32 v140, 16, v203
    v_cvt_pk_bf16_f32 v194, v194, v194
    v_and_b32 v195, 0xffff0000, v203
    v_lshlrev_b32 v141, 16, v204
    v_lshlrev_b32 v142, 16, v205
    v_add_f32 v123, v15, v15
    v_and_b32 v196, 0xffff0000, v204
    v_and_b32 v197, 0xffff0000, v205
    v_add_f32 v178, v15, v15
    v_mul_f32 v124, v15, v140
    v_lshlrev_b32 v139, 16, v139
    v_mul_f32 v179, v15, v195
    v_lshlrev_b32 v194, 16, v194
    v_mul_f32 v107, v123, v141
    v_mul_f32 v108, v123, v142
    v_mul_f32 v162, v178, v196
    v_mul_f32 v163, v178, v197
    v_mul_f32 v124, 0x3e22f983, v124
    v_mul_f32 v123, v15, v139
    v_mul_f32 v179, 0x3e22f983, v179
    v_mul_f32 v178, v15, v194
    v_mul_f32 v123, 0xbfb8aa3b, v123
    v_mul_f32 v126, 0x41000000, v124
    v_mul_f32 v178, 0xbfb8aa3b, v178
    v_mul_f32 v181, 0x41000000, v179
    v_mul_f32 v125, 0x41000000, v123
    v_fract_f32 v126, v126
    v_mul_f32 v180, 0x41000000, v178
    v_fract_f32 v181, v181
    v_exp_f32 v125, v125
    v_cos_f32 v95, v126
    v_sin_f32 v96, v126
    v_exp_f32 v180, v180
    v_cos_f32 v150, v181
    v_sin_f32 v151, v181
    v_mul_f32 v95, v125, v95
    v_mul_f32_e64 v96, -v125, v96
    v_mul_f32 v150, v180, v150
    v_mul_f32_e64 v151, -v180, v151
    v_sub_f32 v97, 0, v96
    v_sub_f32 v152, 0, v151
    v_mul_f32 v98, v95, v95
    v_mul_f32 v99, v95, v96
    v_mul_f32 v153, v150, v150
    v_mul_f32 v154, v150, v151
    v_fmac_f32 v98, v96, v97
    v_fmac_f32 v99, v96, v95
    v_fmac_f32 v153, v151, v152
    v_fmac_f32 v154, v151, v150
    v_sub_f32 v100, 0, v99
    v_sub_f32 v155, 0, v154
    v_mul_f32 v141, v95, v98
    v_mul_f32 v196, v150, v153
    v_mov_b32 v78, 0x3f80
    v_mov_b32 v79, 0x3f80
    v_mul_f32 v139, v98, v98
    v_mul_f32 v194, v153, v153
    v_mul_f32 v142, v95, v99
    v_mul_f32 v197, v150, v154
    v_fmac_f32 v141, v96, v100
    v_fmac_f32 v196, v151, v155
    v_cvt_pk_bf16_f32 v80, v95, v96
    v_cvt_pk_bf16_f32 v81, v150, v151
    ds_write_b64 v10, v[78:79] offset:0
    v_mul_f32 v140, v98, v99
    v_mul_f32 v195, v153, v154
    v_fmac_f32 v139, v99, v100
    v_fmac_f32 v194, v154, v155
    v_fmac_f32 v142, v96, v98
    v_fmac_f32 v197, v151, v153
    v_mul_f32 v145, v141, v98
    v_mul_f32 v200, v196, v153
    v_cvt_pk_bf16_f32 v82, v98, v99
    v_cvt_pk_bf16_f32 v83, v153, v154
    ds_write_b64 v10, v[80:81] offset:544
    v_mul_f32 v146, v141, v99
    v_mul_f32 v201, v196, v154
    v_fmac_f32 v140, v99, v98
    v_fmac_f32 v195, v154, v153
    v_mul_f32 v143, v139, v98
    v_mul_f32 v198, v194, v153
    v_cvt_pk_bf16_f32 v84, v141, v142
    v_cvt_pk_bf16_f32 v85, v196, v197
    v_fmac_f32 v145, v142, v100
    v_fmac_f32 v200, v197, v155
    ds_write_b64 v10, v[82:83] offset:1088
    v_mul_f32 v144, v139, v99
    v_mul_f32 v199, v194, v154
    v_fmac_f32 v146, v142, v98
    v_fmac_f32 v201, v197, v153
    v_cvt_pk_bf16_f32 v86, v139, v140
    v_cvt_pk_bf16_f32 v87, v194, v195
    v_fmac_f32 v143, v140, v100
    v_fmac_f32 v198, v195, v155
    v_mul_f32 v141, v145, v98
    v_mul_f32 v196, v200, v153
    ds_write_b64 v10, v[84:85] offset:1632
    v_mul_f32 v142, v145, v99
    v_mul_f32 v197, v200, v154
    v_fmac_f32 v144, v140, v98
    v_fmac_f32 v199, v195, v153
    v_cvt_pk_bf16_f32 v88, v145, v146
    v_cvt_pk_bf16_f32 v89, v200, v201
    v_mul_f32 v139, v143, v98
    v_mul_f32 v194, v198, v153
    v_fmac_f32 v141, v146, v100
    v_fmac_f32 v196, v201, v155
    ds_write_b64 v10, v[86:87] offset:2176
    v_mul_f32 v140, v143, v99
    v_mul_f32 v195, v198, v154
    v_fmac_f32 v142, v146, v98
    v_fmac_f32 v197, v201, v153
    v_cvt_pk_bf16_f32 v90, v143, v144
    v_cvt_pk_bf16_f32 v91, v198, v199
    v_fmac_f32 v139, v144, v100
    v_fmac_f32 v194, v199, v155
    v_mul_f32 v145, v141, v98
    v_mul_f32 v200, v196, v153
    ds_write_b64 v10, v[88:89] offset:2720
    v_mul_f32 v146, v141, v99
    v_mul_f32 v201, v196, v154
    v_fmac_f32 v140, v144, v98
    v_fmac_f32 v195, v199, v153
    v_cvt_pk_bf16_f32 v76, v141, v142
    v_cvt_pk_bf16_f32 v77, v196, v197
    v_mul_f32 v143, v139, v98
    v_mul_f32 v198, v194, v153
    v_fmac_f32 v145, v142, v100
    v_fmac_f32 v200, v197, v155
    ds_write_b64 v10, v[90:91] offset:3264
    v_mul_f32 v144, v139, v99
    v_mul_f32 v199, v194, v154
    v_fmac_f32 v146, v142, v98
    v_fmac_f32 v201, v197, v153
    v_cvt_pk_bf16_f32 v78, v139, v140
    v_cvt_pk_bf16_f32 v79, v194, v195
    v_fmac_f32 v143, v140, v100
    v_fmac_f32 v198, v195, v155
    v_mul_f32 v141, v145, v98
    v_mul_f32 v196, v200, v153
    ds_write_b64 v10, v[76:77] offset:3808
    v_mul_f32 v142, v145, v99
    v_mul_f32 v197, v200, v154
    v_fmac_f32 v144, v140, v98
    v_fmac_f32 v199, v195, v153
    v_cvt_pk_bf16_f32 v80, v145, v146
    v_cvt_pk_bf16_f32 v81, v200, v201
    v_mul_f32 v139, v143, v98
    v_mul_f32 v194, v198, v153
    ds_write_b64 v10, v[78:79] offset:4352
    v_fmac_f32 v141, v146, v100
    v_fmac_f32 v196, v201, v155
    v_mul_f32 v140, v143, v99
    v_mul_f32 v195, v198, v154
    v_fmac_f32 v142, v146, v98
    v_fmac_f32 v197, v201, v153
    v_cvt_pk_bf16_f32 v82, v143, v144
    v_cvt_pk_bf16_f32 v83, v198, v199
    ds_write_b64 v10, v[80:81] offset:4896
    v_fmac_f32 v139, v144, v100
    v_fmac_f32 v194, v199, v155
    v_mul_f32 v145, v141, v98
    v_mul_f32 v146, v141, v99
    v_mul_f32 v200, v196, v153
    v_mul_f32 v201, v196, v154
    v_fmac_f32 v140, v144, v98
    v_fmac_f32 v195, v199, v153
    v_cvt_pk_bf16_f32 v84, v141, v142
    v_cvt_pk_bf16_f32 v85, v196, v197
    v_fract_f32 v128, v124
    v_fract_f32 v183, v179
    ds_write_b64 v10, v[82:83] offset:5440
    v_mul_f32 v143, v139, v98
    v_mul_f32 v144, v139, v99
    v_mul_f32 v198, v194, v153
    v_mul_f32 v199, v194, v154
    v_fmac_f32 v145, v142, v100
    v_fmac_f32 v146, v142, v98
    v_fmac_f32 v200, v197, v155
    v_fmac_f32 v201, v197, v153
    v_cvt_pk_bf16_f32 v86, v139, v140
    v_cvt_pk_bf16_f32 v87, v194, v195
    v_exp_f32 v127, v123
    v_cos_f32 v92, v128
    v_sin_f32 v93, v128
    v_exp_f32 v182, v178
    v_cos_f32 v147, v183
    v_sin_f32 v148, v183
    ds_write_b64 v10, v[84:85] offset:5984
    v_fmac_f32 v143, v140, v100
    v_fmac_f32 v144, v140, v98
    v_fmac_f32 v198, v195, v155
    v_fmac_f32 v199, v195, v153
    v_cvt_pk_bf16_f32 v88, v145, v146
    v_cvt_pk_bf16_f32 v89, v200, v201
    v_mul_f32 v141, v145, v98
    v_mul_f32 v142, v145, v99
    v_mul_f32 v196, v200, v153
    v_mul_f32 v197, v200, v154
    ds_write_b64 v10, v[86:87] offset:6528
    v_cvt_pk_bf16_f32 v90, v143, v144
    v_cvt_pk_bf16_f32 v91, v198, v199
    v_fmac_f32 v141, v146, v100
    v_fmac_f32 v142, v146, v98
    v_fmac_f32 v196, v201, v155
    v_fmac_f32 v197, v201, v153
    ds_write_b64 v10, v[88:89] offset:7072
    v_mul_f32 v92, v127, v92
    v_mul_f32 v93, v127, v93
    v_mul_f32 v147, v182, v147
    v_mul_f32 v148, v182, v148
    v_cvt_pk_bf16_f32 v76, v141, v142
    v_cvt_pk_bf16_f32 v77, v196, v197
    ds_write_b64 v10, v[90:91] offset:7616
    v_sub_f32 v94, 0, v93
    v_sub_f32 v149, 0, v148
    v_mul_f32 v109, v107, v92
    v_mul_f32 v164, v162, v147
    buffer_load_dwordx4 v[214:217], v5, s[44:47], s59 offen offset:0
    v_mul_f32 v110, v107, v93
    v_mul_f32 v165, v162, v148
    v_fmac_f32 v109, v108, v94
    v_fmac_f32 v164, v163, v149
    ds_write_b64 v10, v[76:77] offset:8160
    v_fmac_f32 v110, v108, v92
    v_fmac_f32 v165, v163, v147
    v_mul_f32 v111, v109, v92
    v_mul_f32 v166, v164, v147
    buffer_load_dwordx4 v[218:221], v5, s[44:47], s59 offen offset:1152
    ds_read_b128 v[28:31], v2 offset:0
    v_mul_f32 v112, v109, v93
    v_mul_f32 v167, v164, v148
    v_fmac_f32 v111, v110, v94
    v_fmac_f32 v166, v165, v149
    ds_read_b128 v[32:35], v2 offset:64
    v_fmac_f32 v112, v110, v92
    v_fmac_f32 v167, v165, v147
    v_mul_f32 v113, v111, v92
    v_mul_f32 v168, v166, v147
    ds_read_b128 v[36:39], v2 offset:128
    ds_read_b128 v[40:43], v2 offset:192
    v_mul_f32 v114, v111, v93
    v_mul_f32 v169, v166, v148
    v_fmac_f32 v113, v112, v94
    v_fmac_f32 v168, v167, v149
    ds_read_b128 v[44:47], v2 offset:256
    v_fmac_f32 v114, v112, v92
    v_fmac_f32 v169, v167, v147
    v_mul_f32 v115, v113, v92
    v_mul_f32 v170, v168, v147
    ds_read_b128 v[48:51], v2 offset:320
    v_cvt_pk_bf16_f32 v78, v107, v108
    v_cvt_pk_bf16_f32 v79, v162, v163
    ds_read_b128 v[52:55], v2 offset:384
    v_mul_f32 v116, v113, v93
    v_mul_f32 v171, v168, v148
    v_fmac_f32 v115, v114, v94
    v_fmac_f32 v170, v169, v149
    ds_read_b128 v[56:59], v2 offset:448
    v_cvt_pk_bf16_f32 v80, v109, v110
    v_cvt_pk_bf16_f32 v81, v164, v165
    v_mul_f32 v130, 0x43000000, v124
    v_mul_f32 v185, 0x43000000, v179
    v_fmac_f32 v116, v114, v92
    v_fmac_f32 v171, v169, v147
    v_mul_f32 v117, v115, v92
    v_mul_f32 v172, v170, v147
    ds_write_b64 v10, v[78:79] offset:0
    v_mul_f32 v129, 0x43000000, v123
    v_fract_f32 v130, v130
    v_mul_f32 v184, 0x43000000, v178
    v_fract_f32 v185, v185
    v_mul_f32 v118, v115, v93
    v_mul_f32 v173, v170, v148
    v_fmac_f32 v117, v116, v94
    v_fmac_f32 v172, v171, v149
    v_cvt_pk_bf16_f32 v82, v111, v112
    v_cvt_pk_bf16_f32 v83, v166, v167
    ds_write_b64 v10, v[80:81] offset:544
    v_exp_f32 v129, v129
    v_cos_f32 v101, v130
    v_sin_f32 v102, v130
    v_exp_f32 v184, v184
    v_cos_f32 v156, v185
    v_sin_f32 v157, v185
    v_cvt_pk_bf16_f32 v84, v113, v114
    v_cvt_pk_bf16_f32 v85, v168, v169
    v_fmac_f32 v118, v116, v92
    v_fmac_f32 v173, v171, v147
    v_mul_f32 v119, v117, v92
    v_mul_f32 v174, v172, v147
    buffer_load_dwordx4 v[222:225], v5, s[44:47], s59 offen offset:2304
    ds_write_b64 v10, v[82:83] offset:1088
    v_mul_f32 v120, v117, v93
    v_mul_f32 v175, v172, v148
    v_fmac_f32 v119, v118, v94
    v_fmac_f32 v174, v173, v149
    v_cvt_pk_bf16_f32 v86, v115, v116
    v_cvt_pk_bf16_f32 v87, v170, v171
    ds_write_b64 v10, v[84:85] offset:1632
    v_mul_f32 v101, v129, v101
    v_mul_f32 v102, v129, v102
    v_mul_f32 v156, v184, v156
    v_mul_f32 v157, v184, v157
    v_fmac_f32 v120, v118, v92
    v_fmac_f32 v175, v173, v147
    v_mul_f32 v121, v119, v92
    v_mul_f32 v122, v119, v93
    v_mul_f32 v176, v174, v147
    v_mul_f32 v177, v174, v148
    v_cvt_pk_bf16_f32 v88, v117, v118
    v_cvt_pk_bf16_f32 v89, v172, v173
    buffer_load_dwordx4 v[226:229], v5, s[44:47], s59 offen offset:3456
    ds_write_b64 v10, v[86:87] offset:2176
    v_sub_f32 v103, 0, v102
    v_sub_f32 v158, 0, v157
    v_mul_f32 v123, v107, v101
    v_mul_f32 v124, v107, v102
    v_mul_f32 v178, v162, v156
    v_mul_f32 v179, v162, v157
    v_fmac_f32 v121, v120, v94
    v_fmac_f32 v122, v120, v92
    v_fmac_f32 v176, v175, v149
    v_fmac_f32 v177, v175, v147
    v_cvt_pk_bf16_f32 v90, v119, v120
    v_cvt_pk_bf16_f32 v91, v174, v175
    ds_write_b64 v10, v[88:89] offset:2720
    v_mul_f32 v125, v109, v101
    v_mul_f32 v126, v109, v102
    v_mul_f32 v180, v164, v156
    v_mul_f32 v181, v164, v157
    v_fmac_f32 v123, v108, v103
    v_fmac_f32 v124, v108, v101
    v_fmac_f32 v178, v163, v158
    v_fmac_f32 v179, v163, v156
    v_cvt_pk_bf16_f32 v76, v121, v122
    v_cvt_pk_bf16_f32 v77, v176, v177
    ds_write_b64 v10, v[90:91] offset:3264
    v_mul_f32 v127, v111, v101
    v_mul_f32 v128, v111, v102
    v_mul_f32 v182, v166, v156
    v_mul_f32 v183, v166, v157
    v_fmac_f32 v125, v110, v103
    v_fmac_f32 v126, v110, v101
    v_fmac_f32 v180, v165, v158
    v_fmac_f32 v181, v165, v156
    v_cvt_pk_bf16_f32 v78, v123, v124
    v_cvt_pk_bf16_f32 v79, v178, v179
    ds_write_b64 v10, v[76:77] offset:3808
    v_mul_f32 v129, v113, v101
    v_mul_f32 v130, v113, v102
    v_mul_f32 v184, v168, v156
    v_mul_f32 v185, v168, v157
    v_fmac_f32 v127, v112, v103
    v_fmac_f32 v128, v112, v101
    v_fmac_f32 v182, v167, v158
    v_fmac_f32 v183, v167, v156
    v_cvt_pk_bf16_f32 v80, v125, v126
    v_cvt_pk_bf16_f32 v81, v180, v181
    ds_write_b64 v10, v[78:79] offset:4352
    v_mul_f32 v131, v115, v101
    v_mul_f32 v132, v115, v102
    v_mul_f32 v186, v170, v156
    v_mul_f32 v187, v170, v157
    v_fmac_f32 v129, v114, v103
    v_fmac_f32 v130, v114, v101
    v_fmac_f32 v184, v169, v158
    v_fmac_f32 v185, v169, v156
    v_cvt_pk_bf16_f32 v82, v127, v128
    v_cvt_pk_bf16_f32 v83, v182, v183
    ds_write_b64 v10, v[80:81] offset:4896
    v_mul_f32 v133, v117, v101
    v_mul_f32 v134, v117, v102
    v_mul_f32 v188, v172, v156
    v_mul_f32 v189, v172, v157
    v_fmac_f32 v131, v116, v103
    v_fmac_f32 v132, v116, v101
    v_fmac_f32 v186, v171, v158
    v_fmac_f32 v187, v171, v156
    v_cvt_pk_bf16_f32 v84, v129, v130
    v_cvt_pk_bf16_f32 v85, v184, v185
    ds_write_b64 v10, v[82:83] offset:5440
    v_fmac_f32 v133, v118, v103
    v_fmac_f32 v134, v118, v101
    v_fmac_f32 v188, v173, v158
    v_fmac_f32 v189, v173, v156
    v_cvt_pk_bf16_f32 v86, v131, v132
    v_cvt_pk_bf16_f32 v87, v186, v187
    v_mul_f32 v135, v119, v101
    v_mul_f32 v136, v119, v102
    v_mul_f32 v190, v174, v156
    v_mul_f32 v191, v174, v157
    ds_write_b64 v10, v[84:85] offset:5984
    v_cvt_pk_bf16_f32 v88, v133, v134
    v_cvt_pk_bf16_f32 v89, v188, v189
    v_mul_f32 v137, v121, v101
    v_mul_f32 v138, v121, v102
    v_mul_f32 v192, v176, v156
    v_mul_f32 v193, v176, v157
    v_fmac_f32 v135, v120, v103
    v_fmac_f32 v136, v120, v101
    v_fmac_f32 v190, v175, v158
    v_fmac_f32 v191, v175, v156
    ds_write_b64 v10, v[86:87] offset:6528
    v_fmac_f32 v137, v122, v103
    v_fmac_f32 v138, v122, v101
    v_fmac_f32 v192, v177, v158
    v_fmac_f32 v193, v177, v156
    v_cvt_pk_bf16_f32 v90, v135, v136
    v_cvt_pk_bf16_f32 v91, v190, v191
    ds_write_b64 v10, v[88:89] offset:7072
    v_cvt_pk_bf16_f32 v76, v137, v138
    v_cvt_pk_bf16_f32 v77, v192, v193
    s_call_b64 s[30:31], LA_tr
    ds_write_b64 v10, v[90:91] offset:7616
    ds_write_b64 v10, v[76:77] offset:8160
    ds_read_b128 v[60:63], v2 offset:0
    ds_read_b128 v[64:67], v2 offset:64
    ds_read_b128 v[68:71], v2 offset:128
    ds_read_b128 v[72:75], v2 offset:192
    v_mul_f32 v104, v101, v101
    v_mul_f32 v105, v101, v102
    v_mul_f32 v159, v156, v156
    v_mul_f32 v160, v156, v157
    v_fmac_f32 v104, v102, v103
    v_fmac_f32 v105, v102, v101
    v_fmac_f32 v159, v157, v158
    v_fmac_f32 v160, v157, v156
    v_sub_f32 v106, 0, v105
    v_sub_f32 v161, 0, v160
    v_mul_f32 v109, v107, v104
    v_mul_f32 v110, v107, v105
    v_mul_f32 v164, v162, v159
    v_mul_f32 v165, v162, v160
    v_mul_f32 v113, v111, v104
    v_mul_f32 v114, v111, v105
    v_mul_f32 v168, v166, v159
    v_mul_f32 v169, v166, v160
    v_fmac_f32 v109, v108, v106
    v_fmac_f32 v110, v108, v104
    v_fmac_f32 v164, v163, v161
    v_fmac_f32 v165, v163, v159
    v_mul_f32 v117, v115, v104
    v_mul_f32 v118, v115, v105
    v_mul_f32 v172, v170, v159
    v_mul_f32 v173, v170, v160
    v_fmac_f32 v113, v112, v106
    s_waitcnt lgkmcnt(3)
    v_mfma_f32_16x16x32_bf16 v[16:19], v[60:63], v[28:31], 0
    s_waitcnt lgkmcnt(2)
    v_mfma_f32_16x16x32_bf16 v[16:19], v[64:67], v[32:35], v[16:19]
    s_waitcnt lgkmcnt(1)
    v_mfma_f32_16x16x32_bf16 v[16:19], v[68:71], v[36:39], v[16:19]
    ds_read_b128 v[60:63], v2 offset:256
    ds_read_b128 v[64:67], v2 offset:320
    s_waitcnt lgkmcnt(2)
    v_mfma_f32_16x16x32_bf16 v[16:19], v[72:75], v[40:43], v[16:19]
    v_fmac_f32 v114, v112, v104
    v_fmac_f32 v168, v167, v161
    v_fmac_f32 v169, v167, v159
    v_cvt_pk_bf16_f32 v78, v109, v110
    v_cvt_pk_bf16_f32 v79, v164, v165
    ds_read_b128 v[68:71], v2 offset:384
    v_mul_f32 v121, v119, v104
    v_mul_f32 v122, v119, v105
    v_mul_f32 v176, v174, v159
    v_mul_f32 v177, v174, v160
    ds_read_b128 v[72:75], v2 offset:448
    v_fmac_f32 v117, v116, v106
    v_fmac_f32 v118, v116, v104
    v_fmac_f32 v172, v171, v161
    v_fmac_f32 v173, v171, v159
    v_cvt_pk_bf16_f32 v80, v113, v114
    v_cvt_pk_bf16_f32 v81, v168, v169
    ds_write_b64 v10, v[78:79] offset:0
    v_fmac_f32 v121, v120, v106
    v_fmac_f32 v122, v120, v104
    v_fmac_f32 v176, v175, v161
    v_fmac_f32 v177, v175, v159
    v_cvt_pk_bf16_f32 v82, v117, v118
    v_cvt_pk_bf16_f32 v83, v172, v173
    v_mul_f32 v125, v123, v104
    v_mul_f32 v126, v123, v105
    v_mul_f32 v180, v178, v159
    v_mul_f32 v181, v178, v160
    ds_write_b64 v10, v[80:81] offset:544
    v_cvt_pk_bf16_f32 v84, v121, v122
    v_cvt_pk_bf16_f32 v85, v176, v177
    v_mul_f32 v129, v127, v104
    v_mul_f32 v130, v127, v105
    v_mul_f32 v184, v182, v159
    v_mul_f32 v185, v182, v160
    v_fmac_f32 v125, v124, v106
    v_fmac_f32 v126, v124, v104
    v_fmac_f32 v180, v179, v161
    v_fmac_f32 v181, v179, v159
    ds_write_b64 v10, v[82:83] offset:1088
    v_mul_f32 v133, v131, v104
    v_mul_f32 v134, v131, v105
    v_mul_f32 v188, v186, v159
    v_mul_f32 v189, v186, v160
    v_fmac_f32 v129, v128, v106
    v_fmac_f32 v130, v128, v104
    v_fmac_f32 v184, v183, v161
    v_fmac_f32 v185, v183, v159
    v_cvt_pk_bf16_f32 v86, v125, v126
    v_cvt_pk_bf16_f32 v87, v180, v181
    ds_write_b64 v10, v[84:85] offset:1632
    v_mul_f32 v137, v135, v104
    v_mul_f32 v138, v135, v105
    v_mul_f32 v192, v190, v159
    v_mul_f32 v193, v190, v160
    v_fmac_f32 v133, v132, v106
    v_fmac_f32 v134, v132, v104
    v_fmac_f32 v188, v187, v161
    v_fmac_f32 v189, v187, v159
    v_cvt_pk_bf16_f32 v88, v129, v130
    v_cvt_pk_bf16_f32 v89, v184, v185
    s_setprio 1
    ds_write_b64 v10, v[86:87] offset:2176
    v_mul_f32 v107, v109, v104
    v_mul_f32 v108, v109, v105
    v_mul_f32 v162, v164, v159
    v_mul_f32 v163, v164, v160
    v_fmac_f32 v137, v136, v106
    v_fmac_f32 v138, v136, v104
    v_fmac_f32 v192, v191, v161
    v_fmac_f32 v193, v191, v159
    v_cvt_pk_bf16_f32 v90, v133, v134
    v_cvt_pk_bf16_f32 v91, v188, v189
    ds_write_b64 v10, v[88:89] offset:2720
    v_mul_f32 v111, v117, v104
    v_mul_f32 v112, v117, v105
    v_mul_f32 v166, v172, v159
    v_mul_f32 v167, v172, v160
    v_fmac_f32 v107, v110, v106
    v_fmac_f32 v108, v110, v104
    v_fmac_f32 v162, v165, v161
    v_fmac_f32 v163, v165, v159
    v_cvt_pk_bf16_f32 v76, v137, v138
    v_cvt_pk_bf16_f32 v77, v192, v193
    ds_write_b64 v10, v[90:91] offset:3264
    v_mul_f32 v115, v125, v104
    v_mul_f32 v116, v125, v105
    v_mul_f32 v170, v180, v159
    v_mul_f32 v171, v180, v160
    v_fmac_f32 v111, v118, v106
    v_fmac_f32 v112, v118, v104
    v_fmac_f32 v166, v173, v161
    v_fmac_f32 v167, v173, v159
    v_cvt_pk_bf16_f32 v78, v107, v108
    v_cvt_pk_bf16_f32 v79, v162, v163
    ds_write_b64 v10, v[76:77] offset:3808
    v_mul_f32 v119, v133, v104
    v_mul_f32 v120, v133, v105
    v_mul_f32 v174, v188, v159
    v_mul_f32 v175, v188, v160
    v_fmac_f32 v115, v126, v106
    v_fmac_f32 v116, v126, v104
    v_fmac_f32 v170, v181, v161
    v_fmac_f32 v171, v181, v159
    v_cvt_pk_bf16_f32 v80, v111, v112
    v_cvt_pk_bf16_f32 v81, v166, v167
    ds_write_b64 v10, v[78:79] offset:4352
    v_mul_f32 v123, v107, v104
    v_mul_f32 v124, v107, v105
    v_mul_f32 v178, v162, v159
    v_mul_f32 v179, v162, v160
    v_fmac_f32 v119, v134, v106
    v_fmac_f32 v120, v134, v104
    v_fmac_f32 v174, v189, v161
    v_fmac_f32 v175, v189, v159
    v_cvt_pk_bf16_f32 v82, v115, v116
    v_cvt_pk_bf16_f32 v83, v170, v171
    ds_write_b64 v10, v[80:81] offset:4896
    v_mul_f32 v127, v111, v104
    v_mul_f32 v128, v111, v105
    v_mul_f32 v182, v166, v159
    v_mul_f32 v183, v166, v160
    v_fmac_f32 v123, v108, v106
    v_fmac_f32 v124, v108, v104
    v_fmac_f32 v178, v163, v161
    v_fmac_f32 v179, v163, v159
    v_cvt_pk_bf16_f32 v84, v119, v120
    v_cvt_pk_bf16_f32 v85, v174, v175
    ds_write_b64 v10, v[82:83] offset:5440
    v_mul_f32 v131, v115, v104
    v_mul_f32 v132, v115, v105
    v_mul_f32 v186, v170, v159
    v_mul_f32 v187, v170, v160
    v_fmac_f32 v127, v112, v106
    v_fmac_f32 v128, v112, v104
    v_fmac_f32 v182, v167, v161
    v_fmac_f32 v183, v167, v159
    v_cvt_pk_bf16_f32 v86, v123, v124
    v_cvt_pk_bf16_f32 v87, v178, v179
    ds_write_b64 v10, v[84:85] offset:5984
    v_mul_f32 v135, v119, v104
    v_mul_f32 v136, v119, v105
    v_mul_f32 v190, v174, v159
    v_mul_f32 v191, v174, v160
    v_fmac_f32 v131, v116, v106
    v_fmac_f32 v132, v116, v104
    v_fmac_f32 v186, v171, v161
    v_fmac_f32 v187, v171, v159
    v_cvt_pk_bf16_f32 v88, v127, v128
    v_cvt_pk_bf16_f32 v89, v182, v183
    ds_write_b64 v10, v[86:87] offset:6528
    v_fmac_f32 v135, v120, v106
    v_fmac_f32 v136, v120, v104
    v_fmac_f32 v190, v175, v161
    v_fmac_f32 v191, v175, v159
    v_cvt_pk_bf16_f32 v90, v131, v132
    v_cvt_pk_bf16_f32 v91, v186, v187
    ds_write_b64 v10, v[88:89] offset:7072
    v_cvt_pk_bf16_f32 v76, v135, v136
    v_cvt_pk_bf16_f32 v77, v190, v191
    ds_write_b64 v10, v[90:91] offset:7616
    s_waitcnt lgkmcnt(15)
    v_mfma_f32_16x16x32_bf16 v[16:19], v[60:63], v[44:47], v[16:19]
    ds_write_b64 v10, v[76:77] offset:8160
    ds_read_b128 v[60:63], v2 offset:0
    s_waitcnt lgkmcnt(15)
    v_mfma_f32_16x16x32_bf16 v[16:19], v[64:67], v[48:51], v[16:19]
    ds_read_b128 v[64:67], v2 offset:64
    s_waitcnt lgkmcnt(15)
    v_mfma_f32_16x16x32_bf16 v[16:19], v[68:71], v[52:55], v[16:19]
    ds_read_b128 v[68:71], v2 offset:128
    s_waitcnt lgkmcnt(15)
    v_mfma_f32_16x16x32_bf16 v[16:19], v[72:75], v[56:59], v[16:19]
    ds_read_b128 v[72:75], v2 offset:192
    v_mul_f32 v139, v123, v104
    v_mul_f32 v194, v178, v159
    v_mul_f32 v140, v123, v105
    v_mul_f32 v195, v178, v160
    v_fmac_f32 v139, v124, v106
    v_fmac_f32 v194, v179, v161
    v_mul_f32 v141, v131, v104
    v_mul_f32 v196, v186, v159
    v_mul_f32 v142, v131, v105
    v_mul_f32 v197, v186, v160
    v_fmac_f32 v140, v124, v104
    v_fmac_f32 v195, v179, v159
    v_mul_f32 v143, v139, v104
    v_mul_f32 v198, v194, v159
    v_fmac_f32 v141, v132, v106
    v_fmac_f32 v196, v187, v161
    v_mul_f32 v144, v139, v105
    v_mul_f32 v199, v194, v160
    v_fmac_f32 v142, v132, v104
    v_fmac_f32 v197, v187, v159
    v_cvt_pk_bf16_f32 v78, v139, v140
    s_waitcnt lgkmcnt(3)
    v_mfma_f32_16x16x32_bf16 v[20:23], v[60:63], v[28:31], 0
    ds_read_b128 v[60:63], v2 offset:256
    s_waitcnt lgkmcnt(3)
    v_mfma_f32_16x16x32_bf16 v[20:23], v[64:67], v[32:35], v[20:23]
    ds_read_b128 v[64:67], v2 offset:320
    s_waitcnt lgkmcnt(3)
    v_mfma_f32_16x16x32_bf16 v[20:23], v[68:71], v[36:39], v[20:23]
    ds_read_b128 v[68:71], v2 offset:384
    s_waitcnt lgkmcnt(3)
    v_mfma_f32_16x16x32_bf16 v[20:23], v[72:75], v[40:43], v[20:23]
    ds_read_b128 v[72:75], v2 offset:448
    v_cvt_pk_bf16_f32 v79, v194, v195
    v_fmac_f32 v143, v140, v106
    v_fmac_f32 v198, v195, v161
    v_mul_f32 v145, v141, v104
    v_mul_f32 v200, v196, v159
    v_mul_f32 v146, v141, v105
    v_mul_f32 v201, v196, v160
    v_fmac_f32 v144, v140, v104
    v_fmac_f32 v199, v195, v159
    v_cvt_pk_bf16_f32 v80, v141, v142
    v_cvt_pk_bf16_f32 v81, v196, v197
    v_mul_f32 v139, v143, v104
    v_mul_f32 v194, v198, v159
    v_fmac_f32 v145, v142, v106
    v_fmac_f32 v200, v197, v161
    ds_write_b64 v10, v[78:79] offset:0
    v_mul_f32 v140, v143, v105
    v_mul_f32 v195, v198, v160
    v_fmac_f32 v146, v142, v104
    v_fmac_f32 v201, v197, v159
    v_cvt_pk_bf16_f32 v82, v143, v144
    v_cvt_pk_bf16_f32 v83, v198, v199
    v_fmac_f32 v139, v144, v106
    v_fmac_f32 v194, v199, v161
    v_mul_f32 v141, v145, v104
    v_mul_f32 v196, v200, v159
    ds_write_b64 v10, v[80:81] offset:544
    v_mul_f32 v142, v145, v105
    v_mul_f32 v197, v200, v160
    v_fmac_f32 v140, v144, v104
    v_fmac_f32 v195, v199, v159
    v_cvt_pk_bf16_f32 v84, v145, v146
    v_cvt_pk_bf16_f32 v85, v200, v201
    v_mul_f32 v143, v139, v104
    v_mul_f32 v198, v194, v159
    ds_write_b64 v10, v[82:83] offset:1088
    v_fmac_f32 v141, v146, v106
    v_fmac_f32 v196, v201, v161
    v_mul_f32 v144, v139, v105
    v_mul_f32 v199, v194, v160
    v_fmac_f32 v142, v146, v104
    v_fmac_f32 v197, v201, v159
    v_cvt_pk_bf16_f32 v86, v139, v140
    v_cvt_pk_bf16_f32 v87, v194, v195
    ds_write_b64 v10, v[84:85] offset:1632
    v_fmac_f32 v143, v140, v106
    v_fmac_f32 v198, v195, v161
    v_mul_f32 v145, v141, v104
    v_mul_f32 v146, v141, v105
    v_mul_f32 v200, v196, v159
    v_mul_f32 v201, v196, v160
    v_fmac_f32 v144, v140, v104
    v_fmac_f32 v199, v195, v159
    v_cvt_pk_bf16_f32 v88, v141, v142
    v_cvt_pk_bf16_f32 v89, v196, v197
    ds_write_b64 v10, v[86:87] offset:2176
    v_mul_f32 v139, v143, v104
    v_mul_f32 v140, v143, v105
    v_mul_f32 v194, v198, v159
    v_mul_f32 v195, v198, v160
    v_fmac_f32 v145, v142, v106
    v_fmac_f32 v146, v142, v104
    v_fmac_f32 v200, v197, v161
    v_fmac_f32 v201, v197, v159
    v_cvt_pk_bf16_f32 v90, v143, v144
    v_cvt_pk_bf16_f32 v91, v198, v199
    ds_write_b64 v10, v[88:89] offset:2720
    v_fmac_f32 v139, v144, v106
    v_fmac_f32 v140, v144, v104
    v_fmac_f32 v194, v199, v161
    v_fmac_f32 v195, v199, v159
    v_cvt_pk_bf16_f32 v76, v145, v146
    v_cvt_pk_bf16_f32 v77, v200, v201
    ds_write_b64 v10, v[90:91] offset:3264
    v_cvt_pk_bf16_f32 v78, v139, v140
    v_cvt_pk_bf16_f32 v79, v194, v195
    ds_write_b64 v10, v[76:77] offset:3808
    s_waitcnt lgkmcnt(11)
    v_mfma_f32_16x16x32_bf16 v[20:23], v[60:63], v[44:47], v[20:23]
    ds_write_b64 v10, v[78:79] offset:4352
    ds_read_b128 v[60:63], v2 offset:0
    s_waitcnt lgkmcnt(12)
    v_mfma_f32_16x16x32_bf16 v[20:23], v[64:67], v[48:51], v[20:23]
    ds_read_b128 v[64:67], v2 offset:64
    s_waitcnt lgkmcnt(12)
    v_mfma_f32_16x16x32_bf16 v[20:23], v[68:71], v[52:55], v[20:23]
    ds_read_b128 v[68:71], v2 offset:128
    s_waitcnt lgkmcnt(12)
    v_mfma_f32_16x16x32_bf16 v[20:23], v[72:75], v[56:59], v[20:23]
    ds_read_b128 v[72:75], v2 offset:192
    s_waitcnt lgkmcnt(3)
    v_mfma_f32_16x16x32_bf16 v[24:27], v[60:63], v[28:31], 0
    ds_read_b128 v[60:63], v2 offset:256
    s_waitcnt lgkmcnt(3)
    v_mfma_f32_16x16x32_bf16 v[24:27], v[64:67], v[32:35], v[24:27]
    ds_read_b128 v[64:67], v2 offset:320
    s_waitcnt lgkmcnt(3)
    v_mfma_f32_16x16x32_bf16 v[24:27], v[68:71], v[36:39], v[24:27]
    ds_read_b128 v[68:71], v2 offset:384
    s_waitcnt lgkmcnt(3)
    v_mfma_f32_16x16x32_bf16 v[24:27], v[72:75], v[40:43], v[24:27]
    ds_read_b128 v[72:75], v2 offset:448
    s_waitcnt lgkmcnt(3)
    v_mfma_f32_16x16x32_bf16 v[24:27], v[60:63], v[44:47], v[24:27]
    s_waitcnt lgkmcnt(2)
    v_mfma_f32_16x16x32_bf16 v[24:27], v[64:67], v[48:51], v[24:27]
    s_waitcnt lgkmcnt(1)
    v_mfma_f32_16x16x32_bf16 v[24:27], v[68:71], v[52:55], v[24:27]
    s_waitcnt lgkmcnt(0)
    v_mfma_f32_16x16x32_bf16 v[24:27], v[72:75], v[56:59], v[24:27]
LA_expand:
    v_and_b32 v12, 15, v0
    v_lshrrev_b32 v13, 4, v0
    v_lshlrev_b32 v3, 9, v13
    v_lshl_add_u32 v3, v12, 4, v3
    s_add_u32 s72, s63, 1844
    v_sub_u32 v3, s72, v3
    s_nop 4
    s_mov_b32 exec_lo, 0
    v_cvt_pk_bf16_f32 v44, v21, v21
    v_cvt_pk_bf16_f32 v45, v21, v20
    v_cvt_pk_bf16_f32 v46, v20, v20
    ds_write2_b32 v3, v44, v45 offset0:64 offset1:65
    ds_write2_b32 v3, v46, v46 offset0:66 offset1:67
    ds_write_b16 v3, v44 offset:2494
    ds_write_b32 v3, v44 offset:2496
    ds_write_b32 v3, v46 offset:2500
    ds_write_b32 v3, v46 offset:2504
    ds_write_b16 v3, v46 offset:2508
    v_cvt_pk_bf16_f32 v47, v23, v23
    v_cvt_pk_bf16_f32 v48, v23, v22
    v_cvt_pk_bf16_f32 v49, v22, v22
    ds_write2_b32 v3, v47, v48 offset0:0 offset1:1
    ds_write2_b32 v3, v49, v49 offset0:2 offset1:3
    ds_write_b16 v3, v47 offset:2238
    ds_write_b32 v3, v47 offset:2240
    ds_write_b32 v3, v49 offset:2244
    ds_write_b32 v3, v49 offset:2248
    ds_write_b16 v3, v49 offset:2252
    s_mov_b64 exec, -1
    v_lshlrev_b32 v3, 8, v13
    v_lshl_add_u32 v3, v12, 4, v3
    s_add_u32 s72, s63, 1584
    v_sub_u32 v3, s72, v3
    s_mov_b32 exec_hi, 0
    v_cvt_pk_bf16_f32 v52, v23, v22
    v_cvt_pk_bf16_f32 v53, v22, v22
    v_cvt_pk_bf16_f32 v54, v21, v20
    v_cvt_pk_bf16_f32 v55, v20, v20
    v_cvt_pk_bf16_f32 v56, v22, v21
    ds_write_b128 v3, v[52:55] offset:2240
    ds_write_b16 v3, v52 offset:2
    ds_write2_b32 v3, v53, v56 offset0:1 offset1:2
    ds_write_b32 v3, v55 offset:12
    ds_write_b16 v3, v55 offset:16
    s_mov_b64 exec, -1
    v_lshrrev_b32 v3, 1, v13
    v_lshlrev_b32 v3, 8, v3
    v_and_b32 v14, 1, v13
    v_lshl_add_u32 v3, v14, 3, v3
    v_lshl_add_u32 v3, v12, 4, v3
    s_add_u32 s72, s63, 2102
    v_sub_u32 v3, s72, v3
    v_cvt_pk_bf16_f32 v58, v19, v18
    v_cvt_pk_bf16_f32 v59, v17, v16
    v_cvt_pk_bf16_f32 v60, v18, v17
    ds_write_b64 v3, v[58:59] offset:2
    ds_write_b16 v3, v58 offset:2240
    ds_write_b32 v3, v60 offset:2242
    ds_write_b16_d16_hi v3, v59 offset:2246
    v_lshrrev_b32 v14, 1, v12
    v_lshl_add_u32 v14, v13, 5, v14
    v_lshlrev_b32 v14, 1, v14
    v_and_b32 v15, 1, v12
    v_mul_u32_u24 v15, 386, v15
    v_add_u32 v14, v14, v15
    s_add_u32 s72, s63, 4944
    v_sub_u32 v3, s72, v14
    v_cvt_pk_bf16_f32 v62, v24, v24
    v_cvt_pk_bf16_f32 v63, v25, v25
    v_cvt_pk_bf16_f32 v64, v26, v26
    v_cvt_pk_bf16_f32 v65, v27, v27
    s_mov_b32 exec_lo, -2
    s_mov_b32 exec_hi, 1
    ds_write_b16 v3, v62 offset:48
    ds_write_b16 v3, v62 offset:238
    s_mov_b32 exec_lo, -1
    s_mov_b32 exec_hi, 0
    ds_write_b16 v3, v63 offset:32
    ds_write_b16 v3, v63 offset:222
    ds_write_b16 v3, v64 offset:16
    ds_write_b16 v3, v64 offset:206
    ds_write_b16 v3, v65 offset:0
    ds_write_b16 v3, v65 offset:190
    s_mov_b32 exec_lo, 1
    v_mov_b32 v3, s63
    ds_write_b16 v3, v62 offset:54
    ds_write2_b32 v3, v62, v62 offset0:14 offset1:15
    ds_write_b32 v3, v62 offset:64
    ds_write_b32 v3, v62 offset:2292
    ds_write_b32 v3, v62 offset:2296
    ds_write_b32 v3, v62 offset:2300
    ds_write_b16 v3, v62 offset:2304
    s_mov_b64 exec, -1
    s_cmp_eq_u32 s78, 1
    s_cbranch_scc1 LA_k8done
    s_cmp_ge_u32 s5, 4
    s_cbranch_scc1 LA_young
    s_call_b64 s[30:31], LA_tr
    v_mov_b32 v16, -1
    v_mov_b32 v17, -1
    v_mov_b32 v18, -1
    v_mov_b32 v19, -1
    s_add_u32 s59, s57, s5
    s_lshl_b32 s59, s59, 12
    s_add_u32 s59, s59, 6291456
    s_add_u32 s60, s59, 16384
    s_add_u32 s61, s56, 512
    s_lshl_b32 s61, s61, 12
    s_add_u32 s61, s61, 6291456
    v_lshlrev_b32 v20, 4, v0
    v_lshlrev_b32 v21, 4, v1
    s_cmp_eq_u32 s5, 3
    s_cbranch_scc0 LA_nojob
    s_call_b64 s[30:31], LA_job
LA_nojob:
    s_setprio 2
    s_lshl_b32 s72, s5, 3
    s_and_b32 s72, s72, 31
    s_lshr_b32 s73, 0xba987f6f, s72
    s_and_b32 s73, s73, 15
    s_add_u32 s73, s73, 127
    s_lshl_b32 s48, s73, 23
    s_cmp_eq_u32 s73, 142
    s_cselect_b32 s48, 0, s48
    s_lshr_b32 s73, 0x77210033, s72
    s_and_b32 s73, s73, 15
    s_add_u32 s73, s73, 127
    s_lshl_b32 s49, s73, 23
    s_lshr_b32 s73, 0x88721144, s72
    s_and_b32 s73, s73, 15
    s_add_u32 s73, s73, 127
    s_lshl_b32 s50, s73, 23
    s_lshr_b32 s73, 0x99872255, s72
    s_and_b32 s73, s73, 15
    s_add_u32 s73, s73, 127
    s_lshl_b32 s51, s73, 23
    s_lshr_b32 s73, 0xba987f6, s72
    s_and_b32 s73, s73, 15
    s_add_u32 s73, s73, 127
    s_lshl_b32 s52, s73, 23
    s_cmp_eq_u32 s73, 142
    s_cselect_b32 s52, 0, s52
    s_lshr_b32 s73, 0x7721003, s72
    s_and_b32 s73, s73, 15
    s_add_u32 s73, s73, 127
    s_lshl_b32 s53, s73, 23
    s_lshr_b32 s73, 0x8872114, s72
    s_and_b32 s73, s73, 15
    s_add_u32 s73, s73, 127
    s_lshl_b32 s54, s73, 23
    s_lshr_b32 s73, 0x9987225, s72
    s_and_b32 s73, s73, 15
    s_add_u32 s73, s73, 127
    s_lshl_b32 s55, s73, 23
    s_mov_b32 s14, 0x3e22f983
    s_cmp_eq_u32 s5, 0
    s_cselect_b64 s[12:13], -1, 0
    s_cselect_b32 s15, 0x80000000, 0
    s_or_b32 s14, s14, s15
    v_lshlrev_b32 v15, 16, v212
    v_mul_f32 v15, 0x3fb8aa3b, v15
    v_exp_f32 v15, v15
    s_nop 0
    v_cvt_pk_bf16_f32 v15, v15, v15
    v_lshlrev_b32 v15, 16, v15
    .p2align 3
    v_lshlrev_b32_e64 v138, 16, v208
    v_and_b32 v188, 0xffff0000, v208
    v_mul_f32 v138, 0x3fb8aa3b, v138
    v_mul_f32 v188, 0x3fb8aa3b, v188
    v_exp_f32_e64 v138, v138
    v_exp_f32_e64 v188, v188
    v_cvt_pk_bf16_f32 v138, v138, v138
    v_lshlrev_b32_e64 v139, 16, v209
    v_cvt_pk_bf16_f32 v188, v188, v188
    v_and_b32 v189, 0xffff0000, v209
    v_lshlrev_b32_e64 v140, 16, v210
    v_lshlrev_b32_e64 v141, 16, v211
    v_add_f32_e64 v134, v15, v15
    v_and_b32 v190, 0xffff0000, v210
    v_and_b32 v191, 0xffff0000, v211
    v_add_f32_e64 v184, v15, v15
    v_mul_f32_e64 v135, v15, v139
    v_lshlrev_b32_e64 v138, 16, v138
    v_mul_f32_e64 v185, v15, v189
    v_lshlrev_b32_e64 v188, 16, v188
    v_mul_f32_e64 v136, v134, v140
    v_mul_f32_e64 v137, v134, v141
    v_mul_f32_e64 v186, v184, v190
    v_mul_f32_e64 v187, v184, v191
    v_mul_f32_e64 v135, s14, v135
    v_mul_f32_e64 v134, v15, v138
    v_mul_f32_e64 v185, s14, v185
    v_mul_f32_e64 v184, v15, v188
    v_mul_f32 v134, 0xbfb8aa3b, v134
    v_mul_f32 v184, 0xbfb8aa3b, v184
    v_mul_f32_e64 v105, s48, v135
    v_mul_f32_e64 v155, s48, v185
    v_mul_f32_e64 v104, s48, v134
    v_fract_f32_e64 v105, v105
    v_mul_f32_e64 v154, s48, v184
    v_fract_f32_e64 v155, v155
    v_exp_f32_e64 v104, v104
    v_cos_f32_e64 v98, v105
    v_sin_f32_e64 v99, v105
    v_exp_f32_e64 v154, v154
    v_cos_f32_e64 v148, v155
    v_sin_f32_e64 v149, v155
    v_mul_f32_e64 v107, s49, v135
    v_mul_f32_e64 v157, s49, v185
    v_mul_f32_e64 v106, s49, v134
    v_fract_f32_e64 v107, v107
    v_mul_f32_e64 v156, s49, v184
    v_fract_f32_e64 v157, v157
    v_cndmask_b32_e64 v136, v136, 1.0, s[12:13]
    v_cndmask_b32_e64 v137, v137, 0, s[12:13]
    v_cndmask_b32_e64 v186, v186, 1.0, s[12:13]
    v_cndmask_b32_e64 v187, v187, 0, s[12:13]
    v_mul_f32_e64 v98, v104, v98
    v_mul_f32_e64 v99, v104, v99
    v_mul_f32_e64 v148, v154, v148
    v_mul_f32_e64 v149, v154, v149
    v_mul_f32_e64 v109, s50, v135
    v_mul_f32_e64 v159, s50, v185
    v_exp_f32_e64 v106, v106
    v_cos_f32_e64 v92, v107
    v_sin_f32_e64 v93, v107
    v_exp_f32_e64 v156, v156
    v_cos_f32_e64 v142, v157
    v_sin_f32_e64 v143, v157
    v_pk_mul_f32 v[102:103], v[136:137], v[98:99] op_sel:[0,0] op_sel_hi:[1,0]
    v_pk_mul_f32 v[152:153], v[186:187], v[148:149] op_sel:[0,0] op_sel_hi:[1,0]
    v_mul_f32_e64 v108, s50, v134
    v_fract_f32_e64 v109, v109
    v_mul_f32_e64 v158, s50, v184
    v_fract_f32_e64 v159, v159
    v_exp_f32_e64 v108, v108
    v_cos_f32_e64 v94, v109
    v_sin_f32_e64 v95, v109
    v_exp_f32_e64 v158, v158
    v_cos_f32_e64 v144, v159
    v_sin_f32_e64 v145, v159
    v_pk_fma_f32 v[102:103], v[136:137], v[98:99], v[102:103] op_sel:[1,1,0] op_sel_hi:[0,1,1] neg_lo:[0,1,0]
    v_pk_fma_f32 v[152:153], v[186:187], v[148:149], v[152:153] op_sel:[1,1,0] op_sel_hi:[0,1,1] neg_lo:[0,1,0]
    v_mul_f32_e64 v92, v106, v92
    v_mul_f32_e64 v93, v106, v93
    v_mul_f32_e64 v142, v156, v142
    v_mul_f32_e64 v143, v156, v143
    v_mul_f32_e64 v111, s51, v135
    v_mul_f32_e64 v161, s51, v185
    v_pk_mul_f32 v[104:105], v[102:103], v[92:93] op_sel:[0,0] op_sel_hi:[1,0]
    v_pk_mul_f32 v[154:155], v[152:153], v[142:143] op_sel:[0,0] op_sel_hi:[1,0]
    v_mul_f32_e64 v110, s51, v134
    v_fract_f32_e64 v111, v111
    v_mul_f32_e64 v160, s51, v184
    v_fract_f32_e64 v161, v161
    v_mul_f32_e64 v94, v108, v94
    v_mul_f32_e64 v95, v108, v95
    v_mul_f32_e64 v144, v158, v144
    v_mul_f32_e64 v145, v158, v145
    v_exp_f32_e64 v110, v110
    v_cos_f32_e64 v96, v111
    v_sin_f32_e64 v97, v111
    v_exp_f32_e64 v160, v160
    v_cos_f32_e64 v146, v161
    v_sin_f32_e64 v147, v161
    v_pk_fma_f32 v[104:105], v[102:103], v[92:93], v[104:105] op_sel:[1,1,0] op_sel_hi:[0,1,1] neg_lo:[0,1,0]
    v_pk_fma_f32 v[154:155], v[152:153], v[142:143], v[154:155] op_sel:[1,1,0] op_sel_hi:[0,1,1] neg_lo:[0,1,0]
    v_pk_mul_f32 v[106:107], v[102:103], v[94:95] op_sel:[0,0] op_sel_hi:[1,0]
    v_pk_mul_f32 v[156:157], v[152:153], v[144:145] op_sel:[0,0] op_sel_hi:[1,0]
    v_cvt_pk_bf16_f32 v80, v102, v103
    v_cvt_pk_bf16_f32 v81, v152, v153
    v_pk_mul_f32 v[108:109], v[104:105], v[94:95] op_sel:[0,0] op_sel_hi:[1,0]
    v_pk_mul_f32 v[158:159], v[154:155], v[144:145] op_sel:[0,0] op_sel_hi:[1,0]
    v_mul_f32_e64 v121, s52, v135
    v_mul_f32_e64 v171, s52, v185
    v_pk_fma_f32 v[106:107], v[102:103], v[94:95], v[106:107] op_sel:[1,1,0] op_sel_hi:[0,1,1] neg_lo:[0,1,0]
    v_pk_fma_f32 v[156:157], v[152:153], v[144:145], v[156:157] op_sel:[1,1,0] op_sel_hi:[0,1,1] neg_lo:[0,1,0]
    v_mul_f32_e64 v96, v110, v96
    v_mul_f32_e64 v97, v110, v97
    v_mul_f32_e64 v146, v160, v146
    v_mul_f32_e64 v147, v160, v147
    v_cvt_pk_bf16_f32 v82, v104, v105
    v_cvt_pk_bf16_f32 v83, v154, v155
    v_mul_f32_e64 v120, s52, v134
    v_fract_f32_e64 v121, v121
    v_mul_f32_e64 v170, s52, v184
    v_fract_f32_e64 v171, v171
    ds_write_b64 v10, v[80:81] offset:0
    v_pk_mul_f32 v[110:111], v[102:103], v[96:97] op_sel:[0,0] op_sel_hi:[1,0]
    v_pk_mul_f32 v[160:161], v[152:153], v[146:147] op_sel:[0,0] op_sel_hi:[1,0]
    v_pk_fma_f32 v[108:109], v[104:105], v[94:95], v[108:109] op_sel:[1,1,0] op_sel_hi:[0,1,1] neg_lo:[0,1,0]
    v_pk_fma_f32 v[158:159], v[154:155], v[144:145], v[158:159] op_sel:[1,1,0] op_sel_hi:[0,1,1] neg_lo:[0,1,0]
    v_cvt_pk_bf16_f32 v84, v106, v107
    v_cvt_pk_bf16_f32 v85, v156, v157
    v_exp_f32_e64 v120, v120
    v_cos_f32_e64 v98, v121
    v_sin_f32_e64 v99, v121
    v_exp_f32_e64 v170, v170
    v_cos_f32_e64 v148, v171
    v_sin_f32_e64 v149, v171
    ds_write_b64 v10, v[82:83] offset:544
    v_pk_mul_f32 v[112:113], v[104:105], v[96:97] op_sel:[0,0] op_sel_hi:[1,0]
    v_pk_mul_f32 v[162:163], v[154:155], v[146:147] op_sel:[0,0] op_sel_hi:[1,0]
    v_pk_fma_f32 v[110:111], v[102:103], v[96:97], v[110:111] op_sel:[1,1,0] op_sel_hi:[0,1,1] neg_lo:[0,1,0]
    v_pk_fma_f32 v[160:161], v[152:153], v[146:147], v[160:161] op_sel:[1,1,0] op_sel_hi:[0,1,1] neg_lo:[0,1,0]
    v_cvt_pk_bf16_f32 v86, v108, v109
    v_cvt_pk_bf16_f32 v87, v158, v159
    v_mul_f32_e64 v123, s53, v135
    v_mul_f32_e64 v173, s53, v185
    ds_write_b64 v10, v[84:85] offset:1088
    buffer_store_dwordx4 v[16:19], v20, s[40:43], s59 offen offset:0 sc0 sc1
    v_mul_f32_e64 v122, s53, v134
    v_fract_f32_e64 v123, v123
    v_mul_f32_e64 v172, s53, v184
    v_fract_f32_e64 v173, v173
    v_pk_mul_f32 v[114:115], v[106:107], v[96:97] op_sel:[0,0] op_sel_hi:[1,0]
    v_pk_mul_f32 v[164:165], v[156:157], v[146:147] op_sel:[0,0] op_sel_hi:[1,0]
    v_mul_f32_e64 v98, v120, v98
    v_mul_f32_e64 v99, v120, v99
    v_mul_f32_e64 v148, v170, v148
    v_mul_f32_e64 v149, v170, v149
    v_pk_fma_f32 v[112:113], v[104:105], v[96:97], v[112:113] op_sel:[1,1,0] op_sel_hi:[0,1,1] neg_lo:[0,1,0]
    v_pk_fma_f32 v[162:163], v[154:155], v[146:147], v[162:163] op_sel:[1,1,0] op_sel_hi:[0,1,1] neg_lo:[0,1,0]
    v_cvt_pk_bf16_f32 v88, v110, v111
    v_cvt_pk_bf16_f32 v89, v160, v161
    ds_write_b64 v10, v[86:87] offset:1632
    v_mul_f32_e64 v125, s54, v135
    v_mul_f32_e64 v175, s54, v185
    v_exp_f32_e64 v122, v122
    v_cos_f32_e64 v92, v123
    v_sin_f32_e64 v93, v123
    v_exp_f32_e64 v172, v172
    v_cos_f32_e64 v142, v173
    v_sin_f32_e64 v143, v173
    v_pk_mul_f32 v[118:119], v[136:137], v[98:99] op_sel:[0,0] op_sel_hi:[1,0]
    v_pk_mul_f32 v[168:169], v[186:187], v[148:149] op_sel:[0,0] op_sel_hi:[1,0]
    buffer_store_dwordx4 v[16:19], v20, s[40:43], s59 offen offset:1024 sc0 sc1
    v_pk_mul_f32 v[116:117], v[108:109], v[96:97] op_sel:[0,0] op_sel_hi:[1,0]
    v_pk_mul_f32 v[166:167], v[158:159], v[146:147] op_sel:[0,0] op_sel_hi:[1,0]
    v_mul_f32_e64 v124, s54, v134
    v_fract_f32_e64 v125, v125
    v_mul_f32_e64 v174, s54, v184
    v_fract_f32_e64 v175, v175
    v_pk_fma_f32 v[114:115], v[106:107], v[96:97], v[114:115] op_sel:[1,1,0] op_sel_hi:[0,1,1] neg_lo:[0,1,0]
    v_pk_fma_f32 v[164:165], v[156:157], v[146:147], v[164:165] op_sel:[1,1,0] op_sel_hi:[0,1,1] neg_lo:[0,1,0]
    v_cvt_pk_bf16_f32 v90, v112, v113
    v_cvt_pk_bf16_f32 v91, v162, v163
    ds_write_b64 v10, v[88:89] offset:2176
    v_exp_f32_e64 v124, v124
    v_cos_f32_e64 v94, v125
    v_sin_f32_e64 v95, v125
    v_exp_f32_e64 v174, v174
    v_cos_f32_e64 v144, v175
    v_sin_f32_e64 v145, v175
    v_pk_fma_f32 v[118:119], v[136:137], v[98:99], v[118:119] op_sel:[1,1,0] op_sel_hi:[0,1,1] neg_lo:[0,1,0]
    v_pk_fma_f32 v[168:169], v[186:187], v[148:149], v[168:169] op_sel:[1,1,0] op_sel_hi:[0,1,1] neg_lo:[0,1,0]
    buffer_store_dwordx4 v[16:19], v20, s[40:43], s59 offen offset:2048 sc0 sc1
    v_mul_f32_e64 v127, s55, v135
    v_mul_f32_e64 v177, s55, v185
    v_pk_fma_f32 v[116:117], v[108:109], v[96:97], v[116:117] op_sel:[1,1,0] op_sel_hi:[0,1,1] neg_lo:[0,1,0]
    v_pk_fma_f32 v[166:167], v[158:159], v[146:147], v[166:167] op_sel:[1,1,0] op_sel_hi:[0,1,1] neg_lo:[0,1,0]
    v_cvt_pk_bf16_f32 v76, v114, v115
    v_cvt_pk_bf16_f32 v77, v164, v165
    v_mul_f32_e64 v92, v122, v92
    v_mul_f32_e64 v93, v122, v93
    v_mul_f32_e64 v142, v172, v142
    v_mul_f32_e64 v143, v172, v143
    ds_write_b64 v10, v[90:91] offset:2720
    v_mul_f32_e64 v126, s55, v134
    v_fract_f32_e64 v127, v127
    v_mul_f32_e64 v176, s55, v184
    v_fract_f32_e64 v177, v177
    buffer_store_dwordx4 v[16:19], v20, s[40:43], s59 offen offset:3072 sc0 sc1
    v_pk_mul_f32 v[120:121], v[118:119], v[92:93] op_sel:[0,0] op_sel_hi:[1,0]
    v_pk_mul_f32 v[170:171], v[168:169], v[142:143] op_sel:[0,0] op_sel_hi:[1,0]
    v_cvt_pk_bf16_f32 v78, v116, v117
    v_cvt_pk_bf16_f32 v79, v166, v167
    ds_write_b64 v10, v[76:77] offset:3264
    v_mul_f32_e64 v94, v124, v94
    v_mul_f32_e64 v95, v124, v95
    v_mul_f32_e64 v144, v174, v144
    v_mul_f32_e64 v145, v174, v145
    v_exp_f32_e64 v126, v126
    v_cos_f32_e64 v96, v127
    v_sin_f32_e64 v97, v127
    v_exp_f32_e64 v176, v176
    v_cos_f32_e64 v146, v177
    v_sin_f32_e64 v147, v177
    buffer_store_dwordx4 v[16:19], v20, s[40:43], s60 offen offset:0 sc0 sc1
    v_pk_fma_f32 v[120:121], v[118:119], v[92:93], v[120:121] op_sel:[1,1,0] op_sel_hi:[0,1,1] neg_lo:[0,1,0]
    v_pk_fma_f32 v[170:171], v[168:169], v[142:143], v[170:171] op_sel:[1,1,0] op_sel_hi:[0,1,1] neg_lo:[0,1,0]
    v_pk_mul_f32 v[122:123], v[118:119], v[94:95] op_sel:[0,0] op_sel_hi:[1,0]
    v_pk_mul_f32 v[172:173], v[168:169], v[144:145] op_sel:[0,0] op_sel_hi:[1,0]
    v_cvt_pk_bf16_f32 v80, v118, v119
    v_cvt_pk_bf16_f32 v81, v168, v169
    ds_write_b64 v10, v[78:79] offset:3808
    buffer_store_dwordx4 v[16:19], v20, s[40:43], s60 offen offset:1024 sc0 sc1
    v_mul_f32_e64 v96, v126, v96
    v_mul_f32_e64 v97, v126, v97
    v_mul_f32_e64 v146, v176, v146
    v_mul_f32_e64 v147, v176, v147
    v_pk_mul_f32 v[124:125], v[120:121], v[94:95] op_sel:[0,0] op_sel_hi:[1,0]
    v_pk_mul_f32 v[174:175], v[170:171], v[144:145] op_sel:[0,0] op_sel_hi:[1,0]
    v_pk_fma_f32 v[122:123], v[118:119], v[94:95], v[122:123] op_sel:[1,1,0] op_sel_hi:[0,1,1] neg_lo:[0,1,0]
    v_pk_fma_f32 v[172:173], v[168:169], v[144:145], v[172:173] op_sel:[1,1,0] op_sel_hi:[0,1,1] neg_lo:[0,1,0]
    v_cvt_pk_bf16_f32 v82, v120, v121
    v_cvt_pk_bf16_f32 v83, v170, v171
    ds_write_b64 v10, v[80:81] offset:4352
    v_pk_mul_f32 v[126:127], v[118:119], v[96:97] op_sel:[0,0] op_sel_hi:[1,0]
    v_pk_mul_f32 v[176:177], v[168:169], v[146:147] op_sel:[0,0] op_sel_hi:[1,0]
    buffer_store_dwordx4 v[16:19], v20, s[40:43], s60 offen offset:2048 sc0 sc1
    v_pk_fma_f32 v[124:125], v[120:121], v[94:95], v[124:125] op_sel:[1,1,0] op_sel_hi:[0,1,1] neg_lo:[0,1,0]
    v_pk_fma_f32 v[174:175], v[170:171], v[144:145], v[174:175] op_sel:[1,1,0] op_sel_hi:[0,1,1] neg_lo:[0,1,0]
    v_cvt_pk_bf16_f32 v84, v122, v123
    v_cvt_pk_bf16_f32 v85, v172, v173
    ds_write_b64 v10, v[82:83] offset:4896
    v_pk_mul_f32 v[128:129], v[120:121], v[96:97] op_sel:[0,0] op_sel_hi:[1,0]
    v_pk_mul_f32 v[178:179], v[170:171], v[146:147] op_sel:[0,0] op_sel_hi:[1,0]
    v_pk_fma_f32 v[126:127], v[118:119], v[96:97], v[126:127] op_sel:[1,1,0] op_sel_hi:[0,1,1] neg_lo:[0,1,0]
    v_pk_fma_f32 v[176:177], v[168:169], v[146:147], v[176:177] op_sel:[1,1,0] op_sel_hi:[0,1,1] neg_lo:[0,1,0]
    buffer_store_dwordx4 v[16:19], v20, s[40:43], s60 offen offset:3072 sc0 sc1
    v_pk_mul_f32 v[130:131], v[122:123], v[96:97] op_sel:[0,0] op_sel_hi:[1,0]
    v_pk_mul_f32 v[180:181], v[172:173], v[146:147] op_sel:[0,0] op_sel_hi:[1,0]
    v_cvt_pk_bf16_f32 v86, v124, v125
    v_cvt_pk_bf16_f32 v87, v174, v175
    ds_write_b64 v10, v[84:85] offset:5440
    v_pk_fma_f32 v[128:129], v[120:121], v[96:97], v[128:129] op_sel:[1,1,0] op_sel_hi:[0,1,1] neg_lo:[0,1,0]
    v_pk_fma_f32 v[178:179], v[170:171], v[146:147], v[178:179] op_sel:[1,1,0] op_sel_hi:[0,1,1] neg_lo:[0,1,0]
    v_pk_mul_f32 v[132:133], v[124:125], v[96:97] op_sel:[0,0] op_sel_hi:[1,0]
    v_pk_mul_f32 v[182:183], v[174:175], v[146:147] op_sel:[0,0] op_sel_hi:[1,0]
    v_cvt_pk_bf16_f32 v88, v126, v127
    v_cvt_pk_bf16_f32 v89, v176, v177
    buffer_store_dwordx4 v[16:19], v21, s[40:43], s61 offen sc0 sc1
    v_pk_fma_f32 v[130:131], v[122:123], v[96:97], v[130:131] op_sel:[1,1,0] op_sel_hi:[0,1,1] neg_lo:[0,1,0]
    v_pk_fma_f32 v[180:181], v[172:173], v[146:147], v[180:181] op_sel:[1,1,0] op_sel_hi:[0,1,1] neg_lo:[0,1,0]
    ds_write_b64 v10, v[86:87] offset:5984
    v_cvt_pk_bf16_f32 v90, v128, v129
    v_cvt_pk_bf16_f32 v91, v178, v179
    v_pk_fma_f32 v[132:133], v[124:125], v[96:97], v[132:133] op_sel:[1,1,0] op_sel_hi:[0,1,1] neg_lo:[0,1,0]
    v_pk_fma_f32 v[182:183], v[174:175], v[146:147], v[182:183] op_sel:[1,1,0] op_sel_hi:[0,1,1] neg_lo:[0,1,0]
    ds_write_b64 v10, v[88:89] offset:6528
    v_cvt_pk_bf16_f32 v76, v130, v131
    v_cvt_pk_bf16_f32 v77, v180, v181
    ds_write_b64 v10, v[90:91] offset:7072
    v_cvt_pk_bf16_f32 v78, v132, v133
    v_cvt_pk_bf16_f32 v79, v182, v183
    ds_write_b64 v10, v[76:77] offset:7616
    ds_write_b64 v10, v[78:79] offset:8160
    v_mov_b32 v12, 163444
    v_mov_b32 v13, 1
    s_mov_b64 exec, 1
    ds_add_u32 v12, v13
    s_mov_b64 exec, -1
    s_cmp_eq_u32 s5, 3
    s_cbranch_scc0 LA_own
    s_call_b64 s[30:31], LA_jflag
    s_branch LA_own
LA_young:
    s_cmp_eq_u32 s5, 6
    s_cbranch_scc0 LA_nof
    v_lshlrev_b32 v4, 7, v0
    v_lshlrev_b32 v5, 4, v0
    s_mov_b32 s74, 720896
    s_mov_b32 s73, 0
LA_up:
    buffer_load_dword v3, v4, s[40:43], s74 offen sc0 sc1
    s_add_u32 s73, s73, 1
    s_waitcnt vmcnt(0)
    v_cmp_ne_u32 vcc, s6, v3
    s_cmp_ge_u32 s73, 40000
    s_cbranch_scc1 LA_upg
    s_cbranch_vccz LA_upg
    s_sleep 6
    s_branch LA_up
LA_upg:
    v_mov_b32 v16, 0
    v_mov_b32 v17, 0
    v_mov_b32 v18, 0
    v_mov_b32 v19, 0
    v_add_u32 v3, 106368, v5
    s_mov_b64 exec, 0x7fffffff
    ds_write_b128 v3, v[16:19]
    s_mov_b64 exec, -1
    s_lshl_b32 s72, s56, 12
    s_add_u32 s72, s72, 9437184
    s_mov_b32 m0, 106864
    s_nop 0
    buffer_load_dwordx4 v5, s[40:43], s72 offen offset:0 sc0 sc1 lds
    buffer_load_dwordx4 v5, s[40:43], s72 offen offset:1024 sc0 sc1 lds
    buffer_load_dwordx4 v5, s[40:43], s72 offen offset:2048 sc0 sc1 lds
    buffer_load_dwordx4 v5, s[40:43], s72 offen offset:3072 sc0 sc1 lds
    s_waitcnt vmcnt(0)
    v_mov_b32 v12, 163456
    v_mov_b32 v13, 1
    s_mov_b64 exec, 1
    ds_add_u32 v12, v13
    s_mov_b64 exec, -1
LA_nof:
    s_cmp_eq_u32 s5, 5
    s_cbranch_scc0 LA_own
    s_setprio 3
    v_mov_b32 v12, 163444
    s_mov_b32 s73, 0
LA_gw:
    ds_read_b32 v13, v12
    s_add_u32 s73, s73, 1
    s_waitcnt lgkmcnt(0)
    v_readfirstlane_b32 s72, v13
    s_cmp_ge_u32 s73, 0x100000
    s_cbranch_scc1 LA_gg
    s_cmp_ge_u32 s72, 4
    s_cbranch_scc1 LA_gg
    s_sleep 1
    s_branch LA_gw
LA_gg:
    v_mov_b32 v2, v6
    v_add_u32 v3, 17408, v6
    ds_read_b128 v[28:31], v2 offset:0
    ds_read_b128 v[32:35], v2 offset:64
    ds_read_b128 v[36:39], v2 offset:128
    ds_read_b128 v[40:43], v2 offset:192
    ds_read_b128 v[44:47], v2 offset:256
    ds_read_b128 v[48:51], v2 offset:320
    ds_read_b128 v[52:55], v2 offset:384
    ds_read_b128 v[56:59], v2 offset:448
    ds_read_b128 v[92:95], v2 offset:8704
    ds_read_b128 v[96:99], v2 offset:8768
    ds_read_b128 v[100:103], v2 offset:8832
    ds_read_b128 v[104:107], v2 offset:8896
    ds_read_b128 v[108:111], v2 offset:8960
    ds_read_b128 v[112:115], v2 offset:9024
    ds_read_b128 v[116:119], v2 offset:9088
    ds_read_b128 v[120:123], v2 offset:9152
    ds_read_b128 v[124:127], v3 offset:0
    ds_read_b128 v[128:131], v3 offset:64
    ds_read_b128 v[132:135], v3 offset:128
    ds_read_b128 v[136:139], v3 offset:192
    ds_read_b128 v[140:143], v3 offset:256
    ds_read_b128 v[144:147], v3 offset:320
    ds_read_b128 v[148:151], v3 offset:384
    ds_read_b128 v[152:155], v3 offset:448
    ds_read_b128 v[156:159], v3 offset:8704
    ds_read_b128 v[160:163], v3 offset:8768
    ds_read_b128 v[164:167], v3 offset:8832
    ds_read_b128 v[168:171], v3 offset:8896
    ds_read_b128 v[172:175], v3 offset:8960
    ds_read_b128 v[176:179], v3 offset:9024
    ds_read_b128 v[180:183], v3 offset:9088
    ds_read_b128 v[184:187], v3 offset:9152
    s_waitcnt lgkmcnt(15)
    v_mfma_f32_16x16x32_bf16 v[16:19], v[92:95], v[28:31], 0
    v_mfma_f32_16x16x32_bf16 v[16:19], v[96:99], v[32:35], v[16:19]
    v_mfma_f32_16x16x32_bf16 v[16:19], v[100:103], v[36:39], v[16:19]
    v_mfma_f32_16x16x32_bf16 v[16:19], v[104:107], v[40:43], v[16:19]
    v_mfma_f32_16x16x32_bf16 v[16:19], v[108:111], v[44:47], v[16:19]
    v_mfma_f32_16x16x32_bf16 v[16:19], v[112:115], v[48:51], v[16:19]
    v_mfma_f32_16x16x32_bf16 v[16:19], v[116:119], v[52:55], v[16:19]
    v_mfma_f32_16x16x32_bf16 v[16:19], v[120:123], v[56:59], v[16:19]
    s_waitcnt lgkmcnt(8)
    v_mfma_f32_16x16x32_bf16 v[20:23], v[124:127], v[28:31], 0
    v_mfma_f32_16x16x32_bf16 v[20:23], v[128:131], v[32:35], v[20:23]
    v_mfma_f32_16x16x32_bf16 v[20:23], v[132:135], v[36:39], v[20:23]
    v_mfma_f32_16x16x32_bf16 v[20:23], v[136:139], v[40:43], v[20:23]
    v_mfma_f32_16x16x32_bf16 v[20:23], v[140:143], v[44:47], v[20:23]
    v_mfma_f32_16x16x32_bf16 v[20:23], v[144:147], v[48:51], v[20:23]
    v_mfma_f32_16x16x32_bf16 v[20:23], v[148:151], v[52:55], v[20:23]
    v_mfma_f32_16x16x32_bf16 v[20:23], v[152:155], v[56:59], v[20:23]
    s_waitcnt lgkmcnt(0)
    v_mfma_f32_16x16x32_bf16 v[24:27], v[156:159], v[28:31], 0
    v_mfma_f32_16x16x32_bf16 v[24:27], v[160:163], v[32:35], v[24:27]
    v_mfma_f32_16x16x32_bf16 v[24:27], v[164:167], v[36:39], v[24:27]
    v_mfma_f32_16x16x32_bf16 v[24:27], v[168:171], v[40:43], v[24:27]
    v_mfma_f32_16x16x32_bf16 v[24:27], v[172:175], v[44:47], v[24:27]
    v_mfma_f32_16x16x32_bf16 v[24:27], v[176:179], v[48:51], v[24:27]
    v_mfma_f32_16x16x32_bf16 v[24:27], v[180:183], v[52:55], v[24:27]
    v_mfma_f32_16x16x32_bf16 v[24:27], v[184:187], v[56:59], v[24:27]
    s_setprio 0
    s_mov_b32 s75, s63
    s_mov_b32 s63, 158192
    s_mov_b32 s78, 1
    s_branch LA_expand
LA_k8done:
    v_mov_b32 v12, 163456
    v_mov_b32 v13, 1
    s_mov_b64 exec, 1
    ds_add_u32 v12, v13
    s_mov_b64 exec, -1
    s_mov_b32 s78, 0
    s_mov_b32 s63, s75
LA_own:
    s_setprio 0
    s_mov_b32 s65, 0
    s_mov_b32 s66, 4
    s_mov_b32 s67, 1
    s_mov_b32 s68, 0
LA_conv:
    v_mul_u32_u24 v248, s70, v244
    v_mul_u32_u24 v249, s70, v245
    v_mul_u32_u24 v250, s70, v246
    v_mul_u32_u24 v251, s70, v247
    s_lshl_b32 s73, s65, 6
    s_add_u32 s72, s64, 464
    s_sub_u32 s72, s72, s73
    v_add_u32 v2, s72, v9
    s_add_u32 s72, s63, 3804
    s_sub_u32 s72, s72, s73
    v_add_u32 v4, s72, v11
    v_subrev_u32 v3, 1024, v4
    v_subrev_u32 v5, 16, v2
    v_subrev_u32 v6, 512, v3
    s_add_u32 s72, s63, 4700
    v_add_u32 v10, s72, v7
    ds_read2_b32 v[80:81], v4 offset0:128 offset1:129
    ds_read2_b32 v[82:83], v4 offset0:130 offset1:131
    ds_read2_b32 v[84:85], v4 offset0:0 offset1:1
    ds_read2_b32 v[86:87], v4 offset0:2 offset1:3
    ds_read2_b32 v[88:89], v3 offset0:128 offset1:129
    ds_read2_b32 v[90:91], v3 offset0:130 offset1:131
    ds_read2_b32 v[92:93], v3 offset0:0 offset1:1
    ds_read2_b32 v[94:95], v3 offset0:2 offset1:3
    ds_read2_b32 v[164:165], v10 offset0:24 offset1:25
    ds_read2_b32 v[166:167], v10 offset0:120 offset1:121
    ds_read2_b32 v[160:161], v6 offset0:0 offset1:1
    ds_read2_b32 v[162:163], v6 offset0:2 offset1:3
    ds_read2_b32 v[168:169], v10 offset0:16 offset1:17
    ds_read2_b32 v[170:171], v10 offset0:112 offset1:113
    ds_read2_b32 v[172:173], v10 offset0:8 offset1:9
    ds_read2_b32 v[174:175], v10 offset0:104 offset1:105
    ds_read2_b32 v[176:177], v10 offset0:0 offset1:1
    ds_read2_b32 v[178:179], v10 offset0:96 offset1:97
    v_mov_b32 v12, 163448
    s_mov_b32 s73, 0
LA_uw:
    ds_read_b32 v13, v12
    s_add_u32 s73, s73, 1
    s_waitcnt lgkmcnt(0)
    v_readfirstlane_b32 s72, v13
    s_cmp_ge_u32 s73, 0x100000
    s_cbranch_scc1 LA_ug
    s_cmp_ge_u32 s72, 8
    s_cbranch_scc1 LA_ug
    s_sleep 1
    s_branch LA_uw
LA_ug:
    s_cmp_eq_u32 s67, 0
    s_cbranch_scc1 LA_plain
    ds_read_b128 v[48:51], v2 offset:0
    ds_read_b128 v[144:147], v5 offset:0
    ds_read_b128 v[52:55], v2 offset:512
    ds_read_b128 v[148:151], v5 offset:512
    ds_read_b128 v[56:59], v2 offset:1024
    ds_read_b128 v[152:155], v5 offset:1024
    ds_read_b128 v[60:63], v2 offset:1536
    ds_read_b128 v[156:159], v5 offset:1536
    ds_read_b128 v[64:67], v2 offset:2048
    ds_read_b128 v[68:71], v2 offset:2560
    ds_read_b128 v[72:75], v2 offset:3072
    ds_read_b128 v[76:79], v2 offset:3584
    s_waitcnt lgkmcnt(11)
    v_mfma_f32_16x16x32_bf16 v[96:99], v[48:51], v[236:239], 0
    s_waitcnt lgkmcnt(10)
    v_mfma_f32_16x16x32_bf16 v[100:103], v[144:147], v[240:243], 0
    s_waitcnt lgkmcnt(9)
    v_mfma_f32_16x16x32_bf16 v[104:107], v[52:55], v[236:239], 0
    s_waitcnt lgkmcnt(8)
    v_mfma_f32_16x16x32_bf16 v[108:111], v[148:151], v[240:243], 0
    s_waitcnt lgkmcnt(7)
    v_mfma_f32_16x16x32_bf16 v[112:115], v[56:59], v[236:239], 0
    s_waitcnt lgkmcnt(6)
    v_mfma_f32_16x16x32_bf16 v[116:119], v[152:155], v[240:243], 0
    s_waitcnt lgkmcnt(5)
    v_mfma_f32_16x16x32_bf16 v[120:123], v[60:63], v[236:239], 0
    s_waitcnt lgkmcnt(4)
    v_mfma_f32_16x16x32_bf16 v[124:127], v[156:159], v[240:243], 0
    v_mfma_f32_16x16x32_bf16 v[16:19], v[248:251], v[48:51], 0
    v_mfma_f32_16x16x32_bf16 v[20:23], v[248:251], v[52:55], 0
    v_mfma_f32_16x16x32_bf16 v[24:27], v[248:251], v[56:59], 0
    v_mfma_f32_16x16x32_bf16 v[28:31], v[248:251], v[60:63], 0
    s_waitcnt lgkmcnt(3)
    v_mfma_f32_16x16x32_bf16 v[32:35], v[248:251], v[64:67], 0
    v_cvt_pk_bf16_f32 v180, v96, v97
    v_cvt_pk_bf16_f32 v181, v98, v99
    s_waitcnt lgkmcnt(2)
    v_mfma_f32_16x16x32_bf16 v[36:39], v[248:251], v[68:71], 0
    v_cvt_pk_bf16_f32 v182, v100, v101
    v_cvt_pk_bf16_f32 v183, v102, v103
    s_waitcnt lgkmcnt(1)
    v_mfma_f32_16x16x32_bf16 v[40:43], v[248:251], v[72:75], 0
    v_cvt_pk_bf16_f32 v184, v104, v105
    v_cvt_pk_bf16_f32 v185, v106, v107
    s_waitcnt lgkmcnt(0)
    v_mfma_f32_16x16x32_bf16 v[44:47], v[248:251], v[76:79], 0
    v_cvt_pk_bf16_f32 v186, v108, v109
    v_cvt_pk_bf16_f32 v187, v110, v111
    v_mfma_f32_16x16x32_bf16 v[32:35], v[160:163], v[48:51], v[32:35]
    v_cvt_pk_bf16_f32 v188, v112, v113
    v_cvt_pk_bf16_f32 v189, v114, v115
    v_mfma_f32_16x16x32_bf16 v[36:39], v[160:163], v[52:55], v[36:39]
    v_cvt_pk_bf16_f32 v190, v116, v117
    v_cvt_pk_bf16_f32 v191, v118, v119
    v_mfma_f32_16x16x32_bf16 v[40:43], v[160:163], v[56:59], v[40:43]
    v_cvt_pk_bf16_f32 v192, v120, v121
    v_cvt_pk_bf16_f32 v193, v122, v123
    v_mfma_f32_16x16x32_bf16 v[44:47], v[160:163], v[60:63], v[44:47]
    v_cvt_pk_bf16_f32 v194, v124, v125
    v_cvt_pk_bf16_f32 v195, v126, v127
    s_branch LA_cloop
LA_plain:
    ds_read_b128 v[48:51], v2 offset:0
    ds_read_b128 v[52:55], v2 offset:512
    ds_read_b128 v[56:59], v2 offset:1024
    ds_read_b128 v[60:63], v2 offset:1536
    ds_read_b128 v[64:67], v2 offset:2048
    ds_read_b128 v[68:71], v2 offset:2560
    ds_read_b128 v[72:75], v2 offset:3072
    ds_read_b128 v[76:79], v2 offset:3584
    s_waitcnt lgkmcnt(7)
    v_mfma_f32_16x16x32_bf16 v[16:19], v[248:251], v[48:51], 0
    s_waitcnt lgkmcnt(6)
    v_mfma_f32_16x16x32_bf16 v[20:23], v[248:251], v[52:55], 0
    s_waitcnt lgkmcnt(5)
    v_mfma_f32_16x16x32_bf16 v[24:27], v[248:251], v[56:59], 0
    s_waitcnt lgkmcnt(4)
    v_mfma_f32_16x16x32_bf16 v[28:31], v[248:251], v[60:63], 0
    s_waitcnt lgkmcnt(3)
    v_mfma_f32_16x16x32_bf16 v[32:35], v[248:251], v[64:67], 0
    s_waitcnt lgkmcnt(2)
    v_mfma_f32_16x16x32_bf16 v[36:39], v[248:251], v[68:71], 0
    s_waitcnt lgkmcnt(1)
    v_mfma_f32_16x16x32_bf16 v[40:43], v[248:251], v[72:75], 0
    s_waitcnt lgkmcnt(0)
    v_mfma_f32_16x16x32_bf16 v[44:47], v[248:251], v[76:79], 0
    .p2align 3
LA_cloop:
    s_waitcnt lgkmcnt(13)
    v_mfma_f32_16x16x32_bf16 v[16:19], v[80:83], v[48:51], v[16:19]
    v_subrev_u32 v4, 64, v4
    v_subrev_u32 v2, 64, v2
    v_subrev_u32 v3, 64, v3
    s_waitcnt lgkmcnt(12)
    v_mfma_f32_16x16x32_bf16 v[20:23], v[80:83], v[52:55], v[20:23]
    ds_read2_b32 v[128:129], v4 offset0:128 offset1:129
    s_waitcnt lgkmcnt(12)
    v_mfma_f32_16x16x32_bf16 v[24:27], v[80:83], v[56:59], v[24:27]
    ds_read2_b32 v[130:131], v4 offset0:130 offset1:131
    s_waitcnt lgkmcnt(12)
    v_mfma_f32_16x16x32_bf16 v[28:31], v[80:83], v[60:63], v[28:31]
    s_waitcnt lgkmcnt(11)
    v_mfma_f32_16x16x32_bf16 v[32:35], v[80:83], v[64:67], v[32:35]
    ds_read_b128 v[96:99], v2 offset:0
    s_waitcnt lgkmcnt(11)
    v_mfma_f32_16x16x32_bf16 v[36:39], v[80:83], v[68:71], v[36:39]
    ds_read_b128 v[100:103], v2 offset:512
    s_waitcnt lgkmcnt(11)
    v_mfma_f32_16x16x32_bf16 v[40:43], v[80:83], v[72:75], v[40:43]
    s_waitcnt lgkmcnt(10)
    v_mfma_f32_16x16x32_bf16 v[44:47], v[80:83], v[76:79], v[44:47]
    ds_read_b128 v[104:107], v2 offset:1024
    s_waitcnt lgkmcnt(9)
    v_mfma_f32_16x16x32_bf16 v[20:23], v[84:87], v[48:51], v[20:23]
    ds_read_b128 v[108:111], v2 offset:1536
    v_mfma_f32_16x16x32_bf16 v[24:27], v[84:87], v[52:55], v[24:27]
    v_mfma_f32_16x16x32_bf16 v[28:31], v[84:87], v[56:59], v[28:31]
    ds_read_b128 v[112:115], v2 offset:2048
    v_mfma_f32_16x16x32_bf16 v[32:35], v[84:87], v[60:63], v[32:35]
    ds_read_b128 v[116:119], v2 offset:2560
    v_mfma_f32_16x16x32_bf16 v[36:39], v[84:87], v[64:67], v[36:39]
    v_mfma_f32_16x16x32_bf16 v[40:43], v[84:87], v[68:71], v[40:43]
    ds_read_b128 v[120:123], v2 offset:3072
    v_mfma_f32_16x16x32_bf16 v[44:47], v[84:87], v[72:75], v[44:47]
    ds_read_b128 v[124:127], v2 offset:3584
    s_waitcnt lgkmcnt(12)
    v_mfma_f32_16x16x32_bf16 v[24:27], v[88:91], v[48:51], v[24:27]
    v_mfma_f32_16x16x32_bf16 v[28:31], v[88:91], v[52:55], v[28:31]
    ds_read2_b32 v[132:133], v4 offset0:0 offset1:1
    v_mfma_f32_16x16x32_bf16 v[32:35], v[88:91], v[56:59], v[32:35]
    ds_read2_b32 v[134:135], v4 offset0:2 offset1:3
    v_mfma_f32_16x16x32_bf16 v[36:39], v[88:91], v[60:63], v[36:39]
    v_mfma_f32_16x16x32_bf16 v[40:43], v[88:91], v[64:67], v[40:43]
    ds_read2_b32 v[136:137], v3 offset0:128 offset1:129
    v_mfma_f32_16x16x32_bf16 v[44:47], v[88:91], v[68:71], v[44:47]
    ds_read2_b32 v[138:139], v3 offset0:130 offset1:131
    s_waitcnt lgkmcnt(14)
    v_mfma_f32_16x16x32_bf16 v[28:31], v[92:95], v[48:51], v[28:31]
    v_mfma_f32_16x16x32_bf16 v[32:35], v[92:95], v[52:55], v[32:35]
    ds_read2_b32 v[140:141], v3 offset0:0 offset1:1
    v_mfma_f32_16x16x32_bf16 v[36:39], v[92:95], v[56:59], v[36:39]
    ds_read2_b32 v[142:143], v3 offset0:2 offset1:3
    v_mfma_f32_16x16x32_bf16 v[40:43], v[92:95], v[60:63], v[40:43]
    v_mfma_f32_16x16x32_bf16 v[44:47], v[92:95], v[64:67], v[44:47]
    s_waitcnt lgkmcnt(13)
    v_mfma_f32_16x16x32_bf16 v[16:19], v[128:131], v[96:99], v[16:19]
    v_subrev_u32 v4, 64, v4
    v_subrev_u32 v2, 64, v2
    v_subrev_u32 v3, 64, v3
    s_waitcnt lgkmcnt(12)
    v_mfma_f32_16x16x32_bf16 v[20:23], v[128:131], v[100:103], v[20:23]
    ds_read2_b32 v[80:81], v4 offset0:128 offset1:129
    s_waitcnt lgkmcnt(12)
    v_mfma_f32_16x16x32_bf16 v[24:27], v[128:131], v[104:107], v[24:27]
    ds_read2_b32 v[82:83], v4 offset0:130 offset1:131
    s_waitcnt lgkmcnt(12)
    v_mfma_f32_16x16x32_bf16 v[28:31], v[128:131], v[108:111], v[28:31]
    s_waitcnt lgkmcnt(11)
    v_mfma_f32_16x16x32_bf16 v[32:35], v[128:131], v[112:115], v[32:35]
    ds_read_b128 v[48:51], v2 offset:0
    s_waitcnt lgkmcnt(11)
    v_mfma_f32_16x16x32_bf16 v[36:39], v[128:131], v[116:119], v[36:39]
    ds_read_b128 v[52:55], v2 offset:512
    s_waitcnt lgkmcnt(11)
    v_mfma_f32_16x16x32_bf16 v[40:43], v[128:131], v[120:123], v[40:43]
    s_waitcnt lgkmcnt(10)
    v_mfma_f32_16x16x32_bf16 v[44:47], v[128:131], v[124:127], v[44:47]
    ds_read_b128 v[56:59], v2 offset:1024
    s_waitcnt lgkmcnt(9)
    v_mfma_f32_16x16x32_bf16 v[20:23], v[132:135], v[96:99], v[20:23]
    ds_read_b128 v[60:63], v2 offset:1536
    v_mfma_f32_16x16x32_bf16 v[24:27], v[132:135], v[100:103], v[24:27]
    v_mfma_f32_16x16x32_bf16 v[28:31], v[132:135], v[104:107], v[28:31]
    ds_read_b128 v[64:67], v2 offset:2048
    v_mfma_f32_16x16x32_bf16 v[32:35], v[132:135], v[108:111], v[32:35]
    ds_read_b128 v[68:71], v2 offset:2560
    v_mfma_f32_16x16x32_bf16 v[36:39], v[132:135], v[112:115], v[36:39]
    v_mfma_f32_16x16x32_bf16 v[40:43], v[132:135], v[116:119], v[40:43]
    ds_read_b128 v[72:75], v2 offset:3072
    v_mfma_f32_16x16x32_bf16 v[44:47], v[132:135], v[120:123], v[44:47]
    ds_read_b128 v[76:79], v2 offset:3584
    s_waitcnt lgkmcnt(12)
    v_mfma_f32_16x16x32_bf16 v[24:27], v[136:139], v[96:99], v[24:27]
    v_mfma_f32_16x16x32_bf16 v[28:31], v[136:139], v[100:103], v[28:31]
    ds_read2_b32 v[84:85], v4 offset0:0 offset1:1
    v_mfma_f32_16x16x32_bf16 v[32:35], v[136:139], v[104:107], v[32:35]
    ds_read2_b32 v[86:87], v4 offset0:2 offset1:3
    v_mfma_f32_16x16x32_bf16 v[36:39], v[136:139], v[108:111], v[36:39]
    v_mfma_f32_16x16x32_bf16 v[40:43], v[136:139], v[112:115], v[40:43]
    ds_read2_b32 v[88:89], v3 offset0:128 offset1:129
    v_mfma_f32_16x16x32_bf16 v[44:47], v[136:139], v[116:119], v[44:47]
    ds_read2_b32 v[90:91], v3 offset0:130 offset1:131
    s_waitcnt lgkmcnt(14)
    v_mfma_f32_16x16x32_bf16 v[28:31], v[140:143], v[96:99], v[28:31]
    v_mfma_f32_16x16x32_bf16 v[32:35], v[140:143], v[100:103], v[32:35]
    ds_read2_b32 v[92:93], v3 offset0:0 offset1:1
    v_mfma_f32_16x16x32_bf16 v[36:39], v[140:143], v[104:107], v[36:39]
    ds_read2_b32 v[94:95], v3 offset0:2 offset1:3
    v_mfma_f32_16x16x32_bf16 v[40:43], v[140:143], v[108:111], v[40:43]
    v_mfma_f32_16x16x32_bf16 v[44:47], v[140:143], v[112:115], v[44:47]
    s_sub_u32 s66, s66, 1
    s_cmp_eq_u32 s66, 0
    s_cbranch_scc0 LA_cloop
    s_cmp_eq_u32 s67, 0
    s_cbranch_scc1 LA_cout
    v_mfma_f32_16x16x32_bf16 v[32:35], v[180:183], v[164:167], v[32:35]
    v_mfma_f32_16x16x32_bf16 v[36:39], v[180:183], v[168:171], v[36:39]
    v_mfma_f32_16x16x32_bf16 v[40:43], v[180:183], v[172:175], v[40:43]
    v_mfma_f32_16x16x32_bf16 v[44:47], v[180:183], v[176:179], v[44:47]
    v_mfma_f32_16x16x32_bf16 v[36:39], v[184:187], v[164:167], v[36:39]
    v_mfma_f32_16x16x32_bf16 v[40:43], v[184:187], v[168:171], v[40:43]
    v_mfma_f32_16x16x32_bf16 v[44:47], v[184:187], v[172:175], v[44:47]
    v_mfma_f32_16x16x32_bf16 v[40:43], v[188:191], v[164:167], v[40:43]
    v_mfma_f32_16x16x32_bf16 v[44:47], v[188:191], v[168:171], v[44:47]
    v_mfma_f32_16x16x32_bf16 v[44:47], v[192:195], v[164:167], v[44:47]
LA_cout:
    s_waitcnt lgkmcnt(0)
    s_nop 7
    s_cmp_eq_u32 s68, 0
    s_cbranch_scc0 LA_pout
    v_add_u32 v10, s63, v8
    v_cvt_pk_bf16_f32 v48, v16, v17
    v_cvt_pk_bf16_f32 v49, v18, v19
    ds_write_b64 v10, v[48:49] offset:0
    v_cvt_pk_bf16_f32 v50, v20, v21
    v_cvt_pk_bf16_f32 v51, v22, v23
    ds_write_b64 v10, v[50:51] offset:512
    v_cvt_pk_bf16_f32 v52, v24, v25
    v_cvt_pk_bf16_f32 v53, v26, v27
    ds_write_b64 v10, v[52:53] offset:1024
    v_cvt_pk_bf16_f32 v54, v28, v29
    v_cvt_pk_bf16_f32 v55, v30, v31
    ds_write_b64 v10, v[54:55] offset:1536
    v_cvt_pk_bf16_f32 v56, v32, v33
    v_cvt_pk_bf16_f32 v57, v34, v35
    ds_write_b64 v10, v[56:57] offset:2048
    v_cvt_pk_bf16_f32 v58, v36, v37
    v_cvt_pk_bf16_f32 v59, v38, v39
    ds_write_b64 v10, v[58:59] offset:2560
    v_cvt_pk_bf16_f32 v60, v40, v41
    v_cvt_pk_bf16_f32 v61, v42, v43
    ds_write_b64 v10, v[60:61] offset:3072
    v_cvt_pk_bf16_f32 v62, v44, v45
    v_cvt_pk_bf16_f32 v63, v46, v47
    ds_write_b64 v10, v[62:63] offset:3584
    s_cmp_ge_u32 s5, 4
    s_cbranch_scc1 LA_mky
    v_mov_b32 v12, 163460
    v_mov_b32 v13, 1
    v_mov_b32 v14, s6
    s_lshl_b32 s73, s56, 7
    s_add_u32 s73, s73, 655360
    v_mov_b32 v15, 0
    s_waitcnt vmcnt(0)
    s_mov_b64 exec, 1
    ds_add_rtn_u32 v13, v12, v13
    s_waitcnt lgkmcnt(0)
    v_readfirstlane_b32 s72, v13
    s_cmp_eq_u32 s72, 3
    s_cbranch_scc0 LA_mk2
    buffer_store_dword v14, v15, s[40:43], s73 offen sc0 sc1
LA_mk2:
    s_mov_b64 exec, -1
    s_branch LA_mkd
LA_mky:
    v_mov_b32 v12, 163460
    s_mov_b32 s73, 0
LA_mmw:
    ds_read_b32 v13, v12
    s_add_u32 s73, s73, 1
    s_waitcnt lgkmcnt(0)
    v_readfirstlane_b32 s72, v13
    s_cmp_ge_u32 s73, 0x100000
    s_cbranch_scc1 LA_mmg
    s_cmp_ge_u32 s72, 4
    s_cbranch_scc1 LA_mmg
    s_sleep 1
    s_branch LA_mmw
LA_mmg:
LA_mkd:
    v_lshl_add_u32 v10, v0, 4, s63
    ds_read_b128 v[64:67], v10 offset:0
    ds_read_b128 v[68:71], v10 offset:1024
    ds_read_b128 v[72:75], v10 offset:2048
    ds_read_b128 v[76:79], v10 offset:3072
    s_add_u32 s72, s57, s71
    s_lshl_b32 s72, s72, 12
    s_add_u32 s72, s72, 6291456
    v_lshlrev_b32 v10, 4, v0
    s_waitcnt lgkmcnt(3)
    buffer_store_dwordx4 v[64:67], v10, s[40:43], s72 offen offset:0 sc0 sc1
    s_waitcnt lgkmcnt(2)
    buffer_store_dwordx4 v[68:71], v10, s[40:43], s72 offen offset:1024 sc0 sc1
    s_waitcnt lgkmcnt(1)
    buffer_store_dwordx4 v[72:75], v10, s[40:43], s72 offen offset:2048 sc0 sc1
    s_waitcnt lgkmcnt(0)
    buffer_store_dwordx4 v[76:79], v10, s[40:43], s72 offen offset:3072 sc0 sc1
    s_cmp_ge_u32 s5, 4
    s_cbranch_scc1 LA_fin
    s_add_u32 s69, s5, 0
    s_and_b32 s69, s69, 3
    s_cmp_eq_u32 s69, 0
    s_cselect_b32 s67, 1, 0
    s_mov_b32 s66, 1
    s_lshl_b32 s65, s69, 1
    s_mov_b32 s68, 1
    s_mov_b32 s63, 158192
    s_mov_b32 s64, 106368
    v_mov_b32 v12, 163456
    s_mov_b32 s73, 0
LA_fw:
    ds_read_b32 v13, v12
    s_add_u32 s73, s73, 1
    s_waitcnt lgkmcnt(0)
    v_readfirstlane_b32 s72, v13
    s_cmp_ge_u32 s73, 0x100000
    s_cbranch_scc1 LA_fg
    s_cmp_ge_u32 s72, 2
    s_cbranch_scc1 LA_fg
    s_sleep 1
    s_branch LA_fw
LA_fg:
    v_readfirstlane_b32 s70, v213
    s_cmp_eq_u32 s69, 0
    s_cselect_b32 s70, s70, 0
    s_nop 1
    s_branch LA_conv
LA_pout:
    v_lshl_add_u32 v10, v8, 1, s62
    ds_write_b128 v10, v[16:19] offset:0
    ds_write_b128 v10, v[20:23] offset:1024
    ds_write_b128 v10, v[24:27] offset:2048
    ds_write_b128 v10, v[28:31] offset:3072
    ds_write_b128 v10, v[32:35] offset:4096
    ds_write_b128 v10, v[36:39] offset:5120
    ds_write_b128 v10, v[40:43] offset:6144
    ds_write_b128 v10, v[44:47] offset:7168
    v_mov_b32 v12, 163452
    v_mov_b32 v13, 1
    s_mov_b64 exec, 1
    ds_add_u32 v12, v13
    s_mov_b64 exec, -1
    v_lshlrev_b32 v2, 5, v1
    v_lshlrev_b32 v3, 4, v1
    s_add_u32 s74, s56, 512
    s_lshl_b32 s74, s74, 12
    s_add_u32 s74, s74, 6291456
    v_mov_b32 v12, 163452
    s_mov_b32 s73, 0
LA_pw:
    ds_read_b32 v13, v12
    s_add_u32 s73, s73, 1
    s_waitcnt lgkmcnt(0)
    v_readfirstlane_b32 s72, v13
    s_cmp_ge_u32 s73, 0x100000
    s_cbranch_scc1 LA_pg
    s_cmp_ge_u32 s72, 4
    s_cbranch_scc1 LA_pg
    s_sleep 1
    s_branch LA_pw
LA_pg:
    ds_read_b128 v[16:19], v2 offset:0
    ds_read_b128 v[20:23], v2 offset:16
    ds_read_b128 v[24:27], v2 offset:8704
    ds_read_b128 v[28:31], v2 offset:8720
    ds_read_b128 v[32:35], v2 offset:17408
    ds_read_b128 v[36:39], v2 offset:17424
    ds_read_b128 v[40:43], v2 offset:26112
    ds_read_b128 v[44:47], v2 offset:26128
    s_waitcnt lgkmcnt(4)
    v_add_f32 v16, v16, v24
    v_add_f32 v17, v17, v25
    v_add_f32 v18, v18, v26
    v_add_f32 v19, v19, v27
    v_add_f32 v20, v20, v28
    v_add_f32 v21, v21, v29
    v_add_f32 v22, v22, v30
    v_add_f32 v23, v23, v31
    s_waitcnt lgkmcnt(2)
    v_add_f32 v16, v16, v32
    v_add_f32 v17, v17, v33
    v_add_f32 v18, v18, v34
    v_add_f32 v19, v19, v35
    v_add_f32 v20, v20, v36
    v_add_f32 v21, v21, v37
    v_add_f32 v22, v22, v38
    v_add_f32 v23, v23, v39
    s_waitcnt lgkmcnt(0)
    v_add_f32 v16, v16, v40
    v_add_f32 v17, v17, v41
    v_add_f32 v18, v18, v42
    v_add_f32 v19, v19, v43
    v_add_f32 v20, v20, v44
    v_add_f32 v21, v21, v45
    v_add_f32 v22, v22, v46
    v_add_f32 v23, v23, v47
    v_cvt_pk_bf16_f32 v48, v16, v17
    v_cvt_pk_bf16_f32 v49, v18, v19
    v_cvt_pk_bf16_f32 v50, v20, v21
    v_cvt_pk_bf16_f32 v51, v22, v23
    buffer_store_dwordx4 v[48:51], v3, s[40:43], s74 offen sc0 sc1
LA_fin:
    s_endpgm
LA_tr:
    s_waitcnt vmcnt(0)
    v_perm_b32 v232, v218, v214, s76
    v_perm_b32 v233, v226, v222, s76
    ds_write_b64 v4, v[232:233] offset:0
    v_perm_b32 v230, v218, v214, s77
    v_perm_b32 v231, v226, v222, s77
    ds_write_b64 v4, v[230:231] offset:4592
    v_perm_b32 v232, v219, v215, s76
    v_perm_b32 v233, v227, v223, s76
    ds_write_b64 v4, v[232:233] offset:9184
    v_perm_b32 v230, v219, v215, s77
    v_perm_b32 v231, v227, v223, s77
    ds_write_b64 v4, v[230:231] offset:13776
    v_perm_b32 v232, v220, v216, s76
    v_perm_b32 v233, v228, v224, s76
    ds_write_b64 v4, v[232:233] offset:18368
    v_perm_b32 v230, v220, v216, s77
    v_perm_b32 v231, v228, v224, s77
    ds_write_b64 v4, v[230:231] offset:22960
    v_perm_b32 v232, v221, v217, s76
    v_perm_b32 v233, v229, v225, s76
    ds_write_b64 v4, v[232:233] offset:27552
    v_perm_b32 v230, v221, v217, s77
    v_perm_b32 v231, v229, v225, s77
    ds_write_b64 v4, v[230:231] offset:32144
    v_mov_b32 v12, 163448
    v_mov_b32 v13, 1
    s_mov_b64 exec, 1
    ds_add_u32 v12, v13
    s_mov_b64 exec, -1
    s_setpc_b64 s[30:31]
LA_job:
    v_lshrrev_b32 v12, 2, v0
    v_and_b32 v13, 3, v0
    v_lshlrev_b32 v3, 7, v12
    v_lshl_add_u32 v3, v13, 3, v3
    v_add_u32 v3, 152944, v3
    v_lshlrev_b32 v14, 12, v12
    v_lshl_add_u32 v14, v13, 4, v14
    v_bfe_u32 v230, v0, 3, 2
    v_lshlrev_b32 v230, 4, v230
    v_lshlrev_b32 v231, 4, v0
    v_xor_b32 v230, v230, v231
    v_add_u32 v230, 106368, v230
    v_and_b32 v12, 15, v0
    v_lshrrev_b32 v13, 4, v0
    v_lshlrev_b32 v12, 6, v12
    v_lshl_add_u32 v12, v13, 3, v12
    v_bfe_u32 v13, v0, 1, 2
    v_lshlrev_b32 v13, 4, v13
    v_xor_b32 v12, v12, v13
    v_xor_b32 v13, 32, v12
    v_add_u32 v12, 106368, v12
    v_add_u32 v13, 106368, v13
    s_lshl_b32 s74, s56, 6
    s_add_u32 s74, s74, 9437184
    ds_read_b64_tr_b16 v[214:215], v3 offset:0
    ds_read_b64_tr_b16 v[216:217], v3 offset:2048
    ds_read_b64_tr_b16 v[218:219], v3 offset:32
    ds_read_b64_tr_b16 v[220:221], v3 offset:2080
    ds_read_b64_tr_b16 v[222:223], v3 offset:64
    ds_read_b64_tr_b16 v[224:225], v3 offset:2112
    ds_read_b64_tr_b16 v[226:227], v3 offset:96
    ds_read_b64_tr_b16 v[228:229], v3 offset:2144
    s_waitcnt lgkmcnt(7)
    ds_write_b64 v12, v[214:215] offset:0
    s_waitcnt lgkmcnt(7)
    ds_write_b64 v13, v[216:217] offset:0
    s_waitcnt lgkmcnt(7)
    ds_write_b64 v12, v[218:219] offset:1024
    s_waitcnt lgkmcnt(7)
    ds_write_b64 v13, v[220:221] offset:1024
    s_waitcnt lgkmcnt(7)
    ds_write_b64 v12, v[222:223] offset:2048
    s_waitcnt lgkmcnt(7)
    ds_write_b64 v13, v[224:225] offset:2048
    s_waitcnt lgkmcnt(7)
    ds_write_b64 v12, v[226:227] offset:3072
    s_waitcnt lgkmcnt(7)
    ds_write_b64 v13, v[228:229] offset:3072
    ds_read_b128 v[214:217], v230 offset:0
    ds_read_b128 v[218:221], v230 offset:1024
    ds_read_b128 v[222:225], v230 offset:2048
    ds_read_b128 v[226:229], v230 offset:3072
    s_add_u32 s72, s74, 0
    s_waitcnt lgkmcnt(3)
    buffer_store_dwordx4 v[214:217], v14, s[40:43], s72 offen sc0 sc1
    s_add_u32 s72, s74, 65536
    s_waitcnt lgkmcnt(2)
    buffer_store_dwordx4 v[218:221], v14, s[40:43], s72 offen sc0 sc1
    s_add_u32 s72, s74, 131072
    s_waitcnt lgkmcnt(1)
    buffer_store_dwordx4 v[222:225], v14, s[40:43], s72 offen sc0 sc1
    s_add_u32 s72, s74, 196608
    s_waitcnt lgkmcnt(0)
    buffer_store_dwordx4 v[226:229], v14, s[40:43], s72 offen sc0 sc1
    s_setpc_b64 s[30:31]
LA_jflag:
    s_lshl_b32 s72, s56, 7
    s_add_u32 s72, s72, 720896
    v_mov_b32 v3, s6
    v_mov_b32 v12, 0
    s_waitcnt vmcnt(9)
    s_mov_b64 exec, 1
    buffer_store_dword v3, v12, s[40:43], s72 offen sc0 sc1
    s_mov_b64 exec, -1
    s_setpc_b64 s[30:31]
Lexit:
    s_endpgm
Lcode_end:

.section .rodata,"a"
.p2align 6
.amdhsa_kernel concat_heads__ssm_conv_s4d__ssm_conv_s5__prompt_kernel
  .amdhsa_next_free_vgpr 256
  .amdhsa_next_free_sgpr 102
  .amdhsa_accum_offset 256
  .amdhsa_group_segment_fixed_size 0
  .amdhsa_kernarg_size 152
  .amdhsa_user_sgpr_count 2
  .amdhsa_user_sgpr_kernarg_segment_ptr 1
  .amdhsa_system_sgpr_workgroup_id_x 1
.end_amdhsa_kernel
```
